```python
import torch

def _softmax(x, axis=-1):
    return torch.softmax(x, dim=axis)
def _gelu(x):
    return torch.nn.functional.gelu(x, approximate="tanh")
def _silu(x):
    return torch.nn.functional.silu(x)
def _sigmoid(x):
    return torch.sigmoid(x)
def _layernorm(x, axis=-1, eps=1e-5):
    m = x.mean(dim=axis, keepdim=True)
    v = x.var(dim=axis, keepdim=True, unbiased=False)
    return (x - m) / torch.sqrt(v + eps)
def _scatter_add(tgt, idx, src, axis=0):
    return tgt.clone().index_add_(axis, idx, src)
def _segment_sum(src, seg, n):
    out = torch.zeros((n,) + src.shape[1:], dtype=src.dtype)
    return out.index_add_(0, seg, src)
def _pad(x, pw):
    flat = tuple(v for pair in reversed(pw) for v in pair)
    return torch.nn.functional.pad(x, flat)

kernel_name = 'recurrent_scan__sliding_block_cached__glu_gated_glu__decode'

def setup_inputs():

    _w = (lambda a: (lambda t: t.to(torch.bfloat16) if t.is_floating_point() else t)(torch.as_tensor(a)))
    def _A_setup():
        B, Sq, D = 8, 1, 512
        Hq, Hkv, Sk, Dh = 32, 8, 8192, 128
        assert Hq % Hkv == 0, (Hq, Hkv)
        return {
            "x": _w((lambda *s: torch.randn(*s, dtype=torch.bfloat16) * 0.05)(B, Sq, D)),
            "k_cache": _w((lambda *s: torch.randn(*s, dtype=torch.bfloat16) * 1.6)(B, Hkv, Sk, Dh)),
            "v_cache": _w((lambda *s: torch.randn(*s, dtype=torch.bfloat16) * 0.2)(B, Hkv, Sk, Dh)),
            "wq": _w((lambda *s: torch.randn(*s, dtype=torch.bfloat16) * 1.6)(D, Hq * Dh) * (D ** -0.5)),
            "wo": _w((lambda *s: torch.randn(*s, dtype=torch.bfloat16) * 0.2)(Hq * Dh, D) * ((Hq * Dh) ** -0.5)),
        }
    _A_in = _A_setup()

    def _B_setup():
        B, S, D, F = 8, 1, 512, 1792
        return {
            "x": _w((lambda *s: torch.randn(*s, dtype=torch.bfloat16) * 0.05)(B, S, D)),
            "w_gate": _w((lambda *s: torch.randn(*s, dtype=torch.bfloat16) * 0.2)(D, F)),
            "w_up": _w((lambda *s: torch.randn(*s, dtype=torch.bfloat16) * 0.1)(D, F)),
            "w_down": _w((lambda *s: torch.randn(*s, dtype=torch.bfloat16) * 0.1)(F, D)),
        }
    _B_in = _B_setup()

    return {
        "A_x": _A_in["x"],
        "A_k_cache": _A_in["k_cache"],
        "A_v_cache": _A_in["v_cache"],
        "A_wq": _A_in["wq"],
        "A_wo": _A_in["wo"],
        "B_x": _B_in["x"],
        "B_w_gate": _B_in["w_gate"],
        "B_w_up": _B_in["w_up"],
        "B_w_down": _B_in["w_down"],
    }

def reference(A_x, A_k_cache, A_v_cache, A_wq, A_wo, B_x, B_w_gate, B_w_up, B_w_down):
    def _A_ref(x, k_cache, v_cache, wq, wo):
        B, Sq, D = x.shape
        Hq, Dh = 32, 128
        Hkv, Sk = k_cache.shape[1], k_cache.shape[2]
        W = min(4096, max(256, Sk // 4))
        rep = Hq // Hkv
        q = (lambda x, *d: x.permute(*d))((x @ wq).reshape(B, Sq, Hq, Dh), 0, 2, 1, 3)
        k = (lambda x, n, axis: torch.repeat_interleave(x, n, dim=axis))(k_cache[:, :, Sk - W:, :], rep, axis=1)
        v = (lambda x, n, axis: torch.repeat_interleave(x, n, dim=axis))(v_cache[:, :, Sk - W:, :], rep, axis=1)
        scores = torch.einsum("bhqd,bhkd->bhqk", q, k) * (Dh ** -0.5)
        p = _softmax(scores, axis=-1)
        o = torch.einsum("bhqk,bhkd->bhqd", p, v)
        return (lambda x, *d: x.permute(*d))(o, 0, 2, 1, 3).reshape(B, Sq, Hq * Dh) @ wo

    def _B_ref(x, w_gate, w_up, w_down):
        g = torch.einsum("bsd,df->bsf", x, w_gate)
        u = torch.einsum("bsd,df->bsf", x, w_up)
        h = _sigmoid(g) * u
        return torch.einsum("bsf,fd->bsd", h, w_down)

    x = A_x
    xn = _layernorm(x, axis=-1)
    s = _A_ref(xn, A_k_cache, A_v_cache, A_wq, A_wo)
    g = _silu(_B_ref(xn, B_w_gate, B_w_up, B_w_down))
    return x + s * g
```

```asm
; @launch grid=(256,1,1) block=(512,1,1) lds=81920
.amdgcn_target "amdgcn-amd-amdhsa--gfx950"
.text
.globl recurrent_scan__sliding_block_cached__glu_gated_glu__decode_kernel
.p2align 8
.type recurrent_scan__sliding_block_cached__glu_gated_glu__decode_kernel,@function
recurrent_scan__sliding_block_cached__glu_gated_glu__decode_kernel:
    s_cmp_ge_u32 s2, 256
    s_cbranch_scc1 L_end
    s_load_dwordx16 s[16:31], s[0:1], 0
    s_load_dwordx8 s[32:39], s[0:1], 64
    v_lshrrev_b32 v4, 6, v0
    s_and_b32 s3, s2, 7
    s_lshr_b32 s2, s2, 3
    s_lshl_b32 s3, s3, 5
    s_or_b32 s2, s2, s3
    v_readfirstlane_b32 s3, v4
    v_and_b32 v0, 63, v0
    v_lshrrev_b32 v1, 4, v0
    v_and_b32 v2, 15, v0
    v_mov_b32 v14, 0
    v_mov_b32 v15, 0
    v_lshlrev_b32 v5, 3, v0
    ds_write_b64 v5, v[14:15] offset:22144
    s_bfe_u32 s56, s2, 196610
    s_lshl_b32 s56, s56, 24
    s_lshr_b32 s57, s2, 5
    s_lshl_b32 s57, s57, 21
    s_add_u32 s56, s56, s57
    s_and_b32 s59, s2, 3
    s_lshl_b32 s57, s59, 17
    s_add_u32 s56, s56, s57
    s_add_u32 s56, s56, 0x180000
    s_and_b32 s58, s3, 3
    s_lshl_b32 s57, s58, 15
    s_add_u32 s56, s56, s57
    s_mov_b32 s6, 32768
    s_mov_b32 s7, 0x20000
    s_mov_b32 s14, 8192
    s_mov_b32 s15, 0x20000
    v_mov_b32 v14, 1
    s_cmp_lt_u32 s3, 4
    s_cbranch_scc1 L_kwave
    s_add_u32 s67, s2, 32
    s_and_b32 s67, s67, 255
    s_cmp_lt_u32 s67, 128
    s_movk_i32 s60, 3584
    s_cselect_b32 s60, 8192, s60
    s_cselect_b32 s61, 0, 128
    s_cmp_lt_u32 s67, 184
    s_cselect_b32 s61, s61, 184
    s_sub_u32 s61, s67, s61
    s_lshr_b32 s61, s61, 1
    s_and_b32 s62, s67, 1
    s_lshl_b32 s63, s62, 8
    s_lshl_b32 s64, s58, 6
    s_add_u32 s63, s63, s64
    s_mul_i32 s64, s63, s60
    s_lshl_b32 s65, s61, 7
    s_add_u32 s64, s64, s65
    v_lshrrev_b32 v6, 3, v0
    v_and_b32 v10, 7, v0
    v_and_b32 v11, 2, v6
    v_xor_b32 v10, v10, v11
    v_xor_b32 v11, 4, v10
    v_mul_lo_u32 v6, v6, s60
    v_lshl_add_u32 v10, v10, 4, v6
    v_lshl_add_u32 v11, v11, 4, v6
    v_lshrrev_b32 v6, 3, v0
    v_and_b32 v7, 7, v0
    v_lshlrev_b32 v5, 10, v6
    v_lshl_add_u32 v5, v7, 4, v5
    s_lshl_b32 s65, s63, 1
    s_lshl_b32 s10, s60, 9
    s_sub_u32 s10, s10, s64
    s_mov_b32 s11, 0x20000
    s_lshl_b32 s69, s60, 3
    s_sub_u32 s70, s69, 1024
    s_lshl_b32 s66, s58, 13
    s_add_u32 s66, s66, 49152
    s_mov_b32 m0, s66
    s_mov_b32 s66, 0
    s_cmp_lt_u32 s67, 184
    s_waitcnt lgkmcnt(0)
    s_cselect_b32 s8, s28, s30
    s_cselect_b32 s9, s29, s31
    s_cmp_lt_u32 s67, 128
    s_cselect_b32 s8, s22, s8
    s_cselect_b32 s9, s23, s9
    s_add_u32 s8, s8, s64
    s_addc_u32 s9, s9, 0
    s_and_b32 s9, s9, 0xffff
    s_mov_b32 s12, s16
    s_and_b32 s13, s17, 0xffff
    s_cmp_ge_u32 s67, 240
    s_cbranch_scc1 L_vstart2
    buffer_load_dwordx4 v10, s[8:11], s66 offen offset:0 nt lds
    s_add_u32 s66, s66, s70
    buffer_load_dwordx4 v11, s[8:11], s66 offen offset:1024 nt lds
    s_add_u32 s66, s66, s70
    buffer_load_dwordx4 v10, s[8:11], s66 offen offset:2048 nt lds
    s_add_u32 s66, s66, s70
    buffer_load_dwordx4 v11, s[8:11], s66 offen offset:3072 nt lds
    s_add_u32 m0, m0, 4096
    s_lshl_b32 s66, s69, 2
    buffer_load_dwordx4 v10, s[8:11], s66 offen offset:0 nt lds
    s_add_u32 s66, s66, s70
    buffer_load_dwordx4 v11, s[8:11], s66 offen offset:1024 nt lds
    s_add_u32 s66, s66, s70
    buffer_load_dwordx4 v10, s[8:11], s66 offen offset:2048 nt lds
    s_add_u32 s66, s66, s70
    buffer_load_dwordx4 v11, s[8:11], s66 offen offset:3072 nt lds
    buffer_load_dwordx4 v[48:51], v5, s[12:15], s65 offen
L_vstart2:
    s_load_dword s40, s[38:39], 0
    s_branch L_vwave
L_kwave:
    v_lshrrev_b32 v4, 2, v2
    v_lshlrev_b32 v4, 8, v4
    v_and_b32 v7, 3, v0
    v_lshl_add_u32 v4, v7, 4, v4
    v_lshl_add_u32 v4, v1, 6, v4
    v_lshrrev_b32 v6, 3, v0
    v_and_b32 v5, 7, v0
    v_lshlrev_b32 v5, 4, v5
    v_lshl_add_u32 v5, v6, 10, v5
    s_waitcnt lgkmcnt(0)
    s_add_u32 s4, s18, s56
    s_addc_u32 s5, s19, 0
    s_and_b32 s5, s5, 0xffff
    s_mov_b32 s12, s16
    s_and_b32 s13, s17, 0xffff
    s_cmp_lg_u32 s3, 3
    s_cbranch_scc1 L_k12
    buffer_load_dwordx4 v[16:19], v5, s[12:15], 0 offen offset:0
    buffer_load_dwordx4 v[20:23], v5, s[12:15], 0 offen offset:128
    buffer_load_dwordx4 v[24:27], v5, s[12:15], 0 offen offset:256
    buffer_load_dwordx4 v[28:31], v5, s[12:15], 0 offen offset:384
    buffer_load_dwordx4 v[32:35], v5, s[12:15], 0 offen offset:512
    buffer_load_dwordx4 v[36:39], v5, s[12:15], 0 offen offset:640
    buffer_load_dwordx4 v[40:43], v5, s[12:15], 0 offen offset:768
    buffer_load_dwordx4 v[44:47], v5, s[12:15], 0 offen offset:896
L_k12:
    s_load_dword s40, s[38:39], 0
    s_mov_b32 s60, 0
    s_mov_b32 s61, 4096
    s_mov_b32 s62, 8192
    s_mov_b32 s63, 12288
    s_mov_b32 s64, 16384
    s_mov_b32 s65, 20480
    s_mov_b32 s66, 24576
    s_mov_b32 s67, 28672
    v_mov_b32 v3, 0xff
    v_mov_b32 v13, 0
    v_mov_b32 v91, 0
    s_lshl_b32 s68, s3, 2
    s_add_i32 s68, s68, 3
    s_barrier
    s_waitcnt lgkmcnt(0)
    s_add_u32 s45, s40, 1
    s_mul_i32 s40, s45, 0x9E3779B1
    s_bfe_u32 s41, s40, 458752
    s_lshl_b32 s41, s41, 1
    s_or_b32 s41, s41, 1
    s_bfe_u32 s42, s40, 458759
    s_lshl_b32 s42, s42, 1
    s_or_b32 s42, s42, 1
    s_bfe_u32 s43, s40, 458766
    s_lshl_b32 s43, s43, 1
    s_or_b32 s43, s43, 1
    s_bfe_u32 s44, s40, 458773
    s_lshl_b32 s44, s44, 1
    s_or_b32 s44, s44, 1
    s_mov_b32 s48, s38
    s_and_b32 s49, s39, 0xffff
    s_mov_b32 s50, 2228224
    s_mov_b32 s51, 0x20000
    s_getreg_b32 s47, hwreg(HW_REG_XCC_ID)
    s_and_b32 s47, s47, 15
    s_and_b32 s57, s40, 0xfffffff0
    s_or_b32 s47, s47, s57
    s_cmp_lg_u32 s3, 2
    s_cbranch_scc1 L_knx
    s_lshl_b32 s57, s2, 2
    s_add_u32 s57, s57, 4096
    v_mov_b32 v8, s47
    s_mov_b64 exec, 1
    buffer_store_dword v8, v15, s[48:51], s57 offen sc1
    s_mov_b64 exec, -1
L_knx:
    s_cmp_lg_u32 s3, 3
    s_cbranch_scc1 L_kissue
    v_mov_b32 v10, 0
    v_mov_b32 v11, 0
    v_mov_b32 v12, 0
    v_mov_b32 v48, 0
    s_mov_b32 s69, 0x3f803f80
    v_lshlrev_b32 v6, 4, v6
    s_mov_b32 s70, 0x01010101
    s_mov_b32 s71, 0x01010101
    s_waitcnt vmcnt(7)
    v_dot2c_f32_bf16 v10, s69, v16
    v_dot2c_f32_bf16 v12, v16, v16
    v_dot2c_f32_bf16 v11, s69, v17
    v_dot2c_f32_bf16 v48, v17, v17
    v_dot2c_f32_bf16 v10, s69, v18
    v_dot2c_f32_bf16 v12, v18, v18
    v_dot2c_f32_bf16 v11, s69, v19
    v_dot2c_f32_bf16 v48, v19, v19
    s_waitcnt vmcnt(6)
    v_dot2c_f32_bf16 v10, s69, v20
    v_dot2c_f32_bf16 v12, v20, v20
    v_dot2c_f32_bf16 v11, s69, v21
    v_dot2c_f32_bf16 v48, v21, v21
    v_dot2c_f32_bf16 v10, s69, v22
    v_dot2c_f32_bf16 v12, v22, v22
    v_dot2c_f32_bf16 v11, s69, v23
    v_dot2c_f32_bf16 v48, v23, v23
    s_waitcnt vmcnt(5)
    v_dot2c_f32_bf16 v10, s69, v24
    v_dot2c_f32_bf16 v12, v24, v24
    v_dot2c_f32_bf16 v11, s69, v25
    v_dot2c_f32_bf16 v48, v25, v25
    v_dot2c_f32_bf16 v10, s69, v26
    v_dot2c_f32_bf16 v12, v26, v26
    v_dot2c_f32_bf16 v11, s69, v27
    v_dot2c_f32_bf16 v48, v27, v27
    s_waitcnt vmcnt(4)
    v_dot2c_f32_bf16 v10, s69, v28
    v_dot2c_f32_bf16 v12, v28, v28
    v_dot2c_f32_bf16 v11, s69, v29
    v_dot2c_f32_bf16 v48, v29, v29
    v_dot2c_f32_bf16 v10, s69, v30
    v_dot2c_f32_bf16 v12, v30, v30
    v_dot2c_f32_bf16 v11, s69, v31
    v_dot2c_f32_bf16 v48, v31, v31
    s_waitcnt vmcnt(3)
    v_dot2c_f32_bf16 v10, s69, v32
    v_dot2c_f32_bf16 v12, v32, v32
    v_dot2c_f32_bf16 v11, s69, v33
    v_dot2c_f32_bf16 v48, v33, v33
    v_dot2c_f32_bf16 v10, s69, v34
    v_dot2c_f32_bf16 v12, v34, v34
    v_dot2c_f32_bf16 v11, s69, v35
    v_dot2c_f32_bf16 v48, v35, v35
    s_waitcnt vmcnt(2)
    v_dot2c_f32_bf16 v10, s69, v36
    v_dot2c_f32_bf16 v12, v36, v36
    v_dot2c_f32_bf16 v11, s69, v37
    v_dot2c_f32_bf16 v48, v37, v37
    v_dot2c_f32_bf16 v10, s69, v38
    v_dot2c_f32_bf16 v12, v38, v38
    v_dot2c_f32_bf16 v11, s69, v39
    v_dot2c_f32_bf16 v48, v39, v39
    s_waitcnt vmcnt(1)
    v_dot2c_f32_bf16 v10, s69, v40
    v_dot2c_f32_bf16 v12, v40, v40
    v_dot2c_f32_bf16 v11, s69, v41
    v_dot2c_f32_bf16 v48, v41, v41
    v_dot2c_f32_bf16 v10, s69, v42
    v_dot2c_f32_bf16 v12, v42, v42
    v_dot2c_f32_bf16 v11, s69, v43
    v_dot2c_f32_bf16 v48, v43, v43
    s_waitcnt vmcnt(0)
    v_dot2c_f32_bf16 v10, s69, v44
    v_dot2c_f32_bf16 v12, v44, v44
    v_dot2c_f32_bf16 v11, s69, v45
    v_dot2c_f32_bf16 v48, v45, v45
    v_dot2c_f32_bf16 v10, s69, v46
    v_dot2c_f32_bf16 v12, v46, v46
    v_dot2c_f32_bf16 v11, s69, v47
    v_dot2c_f32_bf16 v48, v47, v47
    s_nop 1
    v_add_f32 v10, v10, v11
    v_add_f32 v12, v12, v48
    s_nop 0
    v_add_f32_dpp v10, v10, v10 quad_perm:[1,0,3,2] row_mask:0xf bank_mask:0xf
    v_add_f32_dpp v12, v12, v12 quad_perm:[1,0,3,2] row_mask:0xf bank_mask:0xf
    s_nop 0
    v_add_f32_dpp v10, v10, v10 quad_perm:[2,3,0,1] row_mask:0xf bank_mask:0xf
    v_add_f32_dpp v12, v12, v12 quad_perm:[2,3,0,1] row_mask:0xf bank_mask:0xf
    s_nop 0
    v_add_f32_dpp v10, v10, v10 row_half_mirror row_mask:0xf bank_mask:0xf
    v_add_f32_dpp v12, v12, v12 row_half_mirror row_mask:0xf bank_mask:0xf
    v_mul_f32 v10, 989855744, v10
    v_mul_f32 v12, 989855744, v12
    v_fma_f32 v12, -v10, v10, v12
    v_max_f32 v12, 0, v12
    v_cvt_pk_bf16_f32 v16, v10, v10
    v_lshlrev_b32 v16, 16, v16
    v_cvt_pk_bf16_f32 v12, v12, v12
    v_lshlrev_b32 v12, 16, v12
    v_add_f32 v12, 925353388, v12
    v_cvt_pk_bf16_f32 v12, v12, v12
    v_lshlrev_b32 v12, 16, v12
    v_sqrt_f32 v12, v12
    s_nop 0
    v_cvt_pk_bf16_f32 v12, v12, v12
    v_lshlrev_b32 v12, 16, v12
    v_rcp_f32 v17, v12
    v_mov_b32 v18, 1
    v_mov_b32 v19, 0
    s_mov_b64 exec, s[70:71]
    ds_write_b128 v6, v[16:19] offset:22400
    s_mov_b64 exec, -1
L_kissue:
    s_mov_b32 s96, 400000
cr_1:
    ds_read_b32 v8, v15 offset:22576
    s_waitcnt lgkmcnt(0)
    v_readfirstlane_b32 s97, v8
    s_cmp_ge_i32 s97, s68
    s_cbranch_scc1 crd_2
    s_sleep 1
    s_sub_u32 s96, s96, 1
    s_cbranch_scc0 cr_1
crd_2:
    s_add_i32 s68, s68, 1
    buffer_load_dwordx4 v[128:131], v4, s[4:7], s60 offen offset:0 nt
    buffer_load_dwordx4 v[132:135], v4, s[4:7], s60 offen offset:1024 nt
    buffer_load_dwordx4 v[136:139], v4, s[4:7], s60 offen offset:2048 nt
    buffer_load_dwordx4 v[140:143], v4, s[4:7], s60 offen offset:3072 nt
    buffer_load_dwordx4 v[144:147], v4, s[4:7], s61 offen offset:0 nt
    buffer_load_dwordx4 v[148:151], v4, s[4:7], s61 offen offset:1024 nt
    buffer_load_dwordx4 v[152:155], v4, s[4:7], s61 offen offset:2048 nt
    buffer_load_dwordx4 v[156:159], v4, s[4:7], s61 offen offset:3072 nt
    s_mov_b32 s96, 400000
cr_3:
    ds_read_b32 v8, v15 offset:22576
    s_waitcnt lgkmcnt(0)
    v_readfirstlane_b32 s97, v8
    s_cmp_ge_i32 s97, s68
    s_cbranch_scc1 crd_4
    s_sleep 1
    s_sub_u32 s96, s96, 1
    s_cbranch_scc0 cr_3
crd_4:
    s_add_i32 s68, s68, 1
    buffer_load_dwordx4 v[160:163], v4, s[4:7], s62 offen offset:0 nt
    buffer_load_dwordx4 v[164:167], v4, s[4:7], s62 offen offset:1024 nt
    buffer_load_dwordx4 v[168:171], v4, s[4:7], s62 offen offset:2048 nt
    buffer_load_dwordx4 v[172:175], v4, s[4:7], s62 offen offset:3072 nt
    buffer_load_dwordx4 v[176:179], v4, s[4:7], s63 offen offset:0 nt
    buffer_load_dwordx4 v[180:183], v4, s[4:7], s63 offen offset:1024 nt
    buffer_load_dwordx4 v[184:187], v4, s[4:7], s63 offen offset:2048 nt
    buffer_load_dwordx4 v[188:191], v4, s[4:7], s63 offen offset:3072 nt
    s_mov_b32 s96, 400000
cr_5:
    ds_read_b32 v8, v15 offset:22576
    s_waitcnt lgkmcnt(0)
    v_readfirstlane_b32 s97, v8
    s_cmp_ge_i32 s97, s68
    s_cbranch_scc1 crd_6
    s_sleep 1
    s_sub_u32 s96, s96, 1
    s_cbranch_scc0 cr_5
crd_6:
    s_add_i32 s68, s68, 1
    buffer_load_dwordx4 v[192:195], v4, s[4:7], s64 offen offset:0 nt
    buffer_load_dwordx4 v[196:199], v4, s[4:7], s64 offen offset:1024 nt
    buffer_load_dwordx4 v[200:203], v4, s[4:7], s64 offen offset:2048 nt
    buffer_load_dwordx4 v[204:207], v4, s[4:7], s64 offen offset:3072 nt
    buffer_load_dwordx4 v[208:211], v4, s[4:7], s65 offen offset:0 nt
    buffer_load_dwordx4 v[212:215], v4, s[4:7], s65 offen offset:1024 nt
    buffer_load_dwordx4 v[216:219], v4, s[4:7], s65 offen offset:2048 nt
    buffer_load_dwordx4 v[220:223], v4, s[4:7], s65 offen offset:3072 nt
    s_mov_b32 s96, 400000
cr_7:
    ds_read_b32 v8, v15 offset:22576
    s_waitcnt lgkmcnt(0)
    v_readfirstlane_b32 s97, v8
    s_cmp_ge_i32 s97, s68
    s_cbranch_scc1 crd_8
    s_sleep 1
    s_sub_u32 s96, s96, 1
    s_cbranch_scc0 cr_7
crd_8:
    s_add_i32 s68, s68, 1
    buffer_load_dwordx4 v[224:227], v4, s[4:7], s66 offen offset:0 nt
    buffer_load_dwordx4 v[228:231], v4, s[4:7], s66 offen offset:1024 nt
    buffer_load_dwordx4 v[232:235], v4, s[4:7], s66 offen offset:2048 nt
    buffer_load_dwordx4 v[236:239], v4, s[4:7], s66 offen offset:3072 nt
    buffer_load_dwordx4 v[240:243], v4, s[4:7], s67 offen offset:0 nt
    buffer_load_dwordx4 v[244:247], v4, s[4:7], s67 offen offset:1024 nt
    buffer_load_dwordx4 v[248:251], v4, s[4:7], s67 offen offset:2048 nt
    buffer_load_dwordx4 v[252:255], v4, s[4:7], s67 offen offset:3072 nt
    s_lshr_b32 s56, s2, 3
    s_lshl_b32 s57, s56, 14
    s_lshl_b32 s58, s3, 11
    s_add_u32 s46, s57, s58
    s_add_u32 s46, s46, 589824
    v_and_b32 v90, 3, v0
    v_lshrrev_b32 v8, 2, v0
    v_lshlrev_b32 v84, 4, v0
    s_lshl_b32 s58, s3, 4
    v_lshl_add_u32 v85, v90, 2, s58
    s_mul_i32 s57, s3, 272
    v_lshl_add_u32 v86, v8, 3, s57
    v_and_b32 v87, 7, v2
    v_mul_u32_u24 v87, 272, v87
    v_lshl_add_u32 v87, v1, 4, v87
    s_and_b32 s57, s2, 7
    s_lshl_b32 s57, s57, 16
    s_lshl_b32 s58, s56, 11
    s_add_u32 s57, s57, s58
    s_and_b32 s58, s3, 3
    s_lshl_b32 s58, s58, 9
    s_add_u32 s57, s57, s58
    s_add_u32 s1, s57, 1179648
    v_lshlrev_b32 v89, 6, v2
    v_lshl_add_u32 v89, v1, 4, v89
    v_lshrrev_b32 v8, 2, v2
    v_lshl_add_u32 v88, v1, 3, v8
    v_lshlrev_b32 v88, 7, v88
    v_lshrrev_b32 v8, 1, v8
    v_and_b32 v9, 1, v1
    v_lshl_or_b32 v8, v9, 1, v8
    v_lshl_add_u32 v88, v8, 5, v88
    v_lshl_add_u32 v88, v90, 3, v88
    s_waitcnt vmcnt(24)
    s_mov_b64 exec, 1
    ds_add_u32 v15, v14 offset:22576
    s_mov_b64 exec, -1
    s_waitcnt vmcnt(16)
    s_mov_b64 exec, 1
    ds_add_u32 v15, v14 offset:22576
    s_mov_b64 exec, -1
    s_waitcnt vmcnt(8)
    s_mov_b64 exec, 1
    ds_add_u32 v15, v14 offset:22576
    s_mov_b64 exec, -1
    s_waitcnt vmcnt(0)
    s_mov_b64 exec, 1
    ds_add_u32 v15, v14 offset:22576
    s_mov_b64 exec, -1
    s_cmp_lg_u32 s3, 0
    s_cbranch_scc1 L_kqk
    s_lshr_b32 s56, s2, 5
    s_lshl_b32 s57, s56, 14
    s_bfe_u32 s58, s2, 196610
    s_lshl_b32 s58, s58, 6
    s_add_u32 s57, s57, s58
    s_add_u32 s60, s57, 65536
    s_add_u32 s61, s60, 8192
    s_add_u32 s62, s60, 245760
    s_add_u32 s63, s61, 245760
    v_lshrrev_b32 v6, 2, v0
    v_lshlrev_b32 v5, 9, v6
    v_lshl_add_u32 v5, v90, 4, v5
    s_lshl_b32 s64, s56, 7
    s_add_u32 s64, s64, 4096
    v_and_b32 v10, 31, v0
    v_lshlrev_b32 v10, 2, v10
    s_mov_b32 s96, 40000
poll_9:
    buffer_load_dwordx4 v[24:27], v5, s[48:51], s60 offen sc1
    buffer_load_dwordx4 v[28:31], v5, s[48:51], s61 offen sc1
    buffer_load_dwordx4 v[32:35], v5, s[48:51], s62 offen sc1
    buffer_load_dwordx4 v[36:39], v5, s[48:51], s63 offen sc1
    s_waitcnt vmcnt(3)
    v_msad_u8 v8, v24, s41, 0
    v_msad_u8 v8, v25, s42, v8
    v_msad_u8 v8, v26, s43, v8
    v_msad_u8 v8, v27, s44, v8
    s_waitcnt vmcnt(2)
    v_msad_u8 v8, v28, s41, v8
    v_msad_u8 v8, v29, s42, v8
    v_msad_u8 v8, v30, s43, v8
    v_msad_u8 v8, v31, s44, v8
    s_waitcnt vmcnt(1)
    v_msad_u8 v8, v32, s41, v8
    v_msad_u8 v8, v33, s42, v8
    v_msad_u8 v8, v34, s43, v8
    v_msad_u8 v8, v35, s44, v8
    s_waitcnt vmcnt(0)
    v_msad_u8 v8, v36, s41, v8
    v_msad_u8 v8, v37, s42, v8
    v_msad_u8 v8, v38, s43, v8
    v_msad_u8 v8, v39, s44, v8
    v_cmp_ne_u32 vcc, 0, v8
    s_cbranch_vccz polld_10
    s_sleep 2
    s_sub_u32 s96, s96, 1
    s_cbranch_scc0 poll_9
polld_10:
    buffer_load_dword v40, v10, s[48:51], s64 offen sc1
    v_add_f32 v24, v24, v32
    v_add_f32 v25, v25, v33
    v_add_f32 v26, v26, v34
    v_add_f32 v27, v27, v35
    v_add_f32 v28, v28, v36
    v_add_f32 v29, v29, v37
    v_add_f32 v30, v30, v38
    v_add_f32 v31, v31, v39
    v_cvt_pk_bf16_f32 v32, v24, v25
    v_cvt_pk_bf16_f32 v33, v26, v27
    v_cvt_pk_bf16_f32 v34, v28, v29
    v_cvt_pk_bf16_f32 v35, v30, v31
    v_lshrrev_b32 v8, 5, v0
    v_mul_u32_u24 v8, 272, v8
    v_and_b32 v9, 31, v0
    v_lshl_add_u32 v8, v9, 3, v8
    ds_write_b64 v8, v[32:33] offset:4224
    ds_write_b64 v8, v[34:35] offset:4768
    v_mov_b32 v9, 22544
    s_mov_b64 exec, 1
    ds_write_b32 v9, v14
    s_mov_b64 exec, -1
    s_mov_b32 s96, 40000
L_xs:
    s_waitcnt vmcnt(0)
    v_xor_b32 v40, s47, v40
    v_cmp_lt_u32 vcc, 15, v40
    s_cbranch_vccz L_xsd
    s_sleep 4
    buffer_load_dword v40, v10, s[48:51], s64 offen sc1
    s_sub_u32 s96, s96, 1
    s_cbranch_scc0 L_xs
    s_waitcnt vmcnt(0)
L_xsd:
    v_cmp_ne_u32 vcc, 0, v40
    s_cmp_eq_u64 vcc, 0
    s_cselect_b32 s57, 2, 1
    v_mov_b32 v8, s57
    ds_write_b32 v15, v8 offset:22592
    s_branch L_kqk2
L_kqk:
    s_mov_b32 s96, 400000
spin_11:
    ds_read_b32 v8, v15 offset:22544
    s_waitcnt lgkmcnt(0)
    v_cmp_ne_u32 vcc, 1, v8
    s_cbranch_vccz spind_12
    s_sleep 2
    s_sub_u32 s96, s96, 1
    s_cbranch_scc0 spin_11
spind_12:
L_kqk2:
    v_lshrrev_b32 v6, 2, v2
    v_mul_u32_u24 v5, 272, v7
    v_lshl_add_u32 v5, v1, 6, v5
    v_lshl_add_u32 v5, v6, 4, v5
    ds_read_b128 v[24:27], v5 offset:4224
    s_mov_b32 s57, 1035273459
    s_mov_b32 s69, 1069066811
    s_waitcnt lgkmcnt(0)
    v_mfma_f32_16x16x32_bf16 v[32:35], v[128:131], v[24:27], 0
    v_mfma_f32_16x16x32_bf16 v[36:39], v[132:135], v[24:27], 0
    v_mfma_f32_16x16x32_bf16 v[40:43], v[136:139], v[24:27], 0
    v_mfma_f32_16x16x32_bf16 v[44:47], v[140:143], v[24:27], 0
    v_mfma_f32_16x16x32_bf16 v[48:51], v[144:147], v[24:27], 0
    v_mfma_f32_16x16x32_bf16 v[52:55], v[148:151], v[24:27], 0
    v_mfma_f32_16x16x32_bf16 v[56:59], v[152:155], v[24:27], 0
    v_mfma_f32_16x16x32_bf16 v[60:63], v[156:159], v[24:27], 0
    s_nop 0
    v_mov_b32_dpp v16, v32 quad_perm:[0,1,2,3] row_mask:0xf bank_mask:0x1
    v_add_f32_dpp v16, v33, v16 row_ror:12 row_mask:0xf bank_mask:0x1
    v_add_f32_dpp v16, v34, v16 row_ror:8 row_mask:0xf bank_mask:0x1
    v_add_f32_dpp v16, v35, v16 row_ror:4 row_mask:0xf bank_mask:0x1
    v_mov_b32_dpp v16, v36 row_ror:4 row_mask:0xf bank_mask:0x2
    v_add_f32_dpp v16, v37, v16 quad_perm:[0,1,2,3] row_mask:0xf bank_mask:0x2
    v_add_f32_dpp v16, v38, v16 row_ror:12 row_mask:0xf bank_mask:0x2
    v_add_f32_dpp v16, v39, v16 row_ror:8 row_mask:0xf bank_mask:0x2
    v_mov_b32_dpp v16, v40 row_ror:8 row_mask:0xf bank_mask:0x4
    v_add_f32_dpp v16, v41, v16 row_ror:4 row_mask:0xf bank_mask:0x4
    v_add_f32_dpp v16, v42, v16 quad_perm:[0,1,2,3] row_mask:0xf bank_mask:0x4
    v_add_f32_dpp v16, v43, v16 row_ror:12 row_mask:0xf bank_mask:0x4
    v_mov_b32_dpp v16, v44 row_ror:12 row_mask:0xf bank_mask:0x8
    v_add_f32_dpp v16, v45, v16 row_ror:8 row_mask:0xf bank_mask:0x8
    v_add_f32_dpp v16, v46, v16 row_ror:4 row_mask:0xf bank_mask:0x8
    v_add_f32_dpp v16, v47, v16 quad_perm:[0,1,2,3] row_mask:0xf bank_mask:0x8
    v_mfma_f32_16x16x32_bf16 v[32:35], v[160:163], v[24:27], 0
    v_mfma_f32_16x16x32_bf16 v[36:39], v[164:167], v[24:27], 0
    v_mfma_f32_16x16x32_bf16 v[40:43], v[168:171], v[24:27], 0
    v_mfma_f32_16x16x32_bf16 v[44:47], v[172:175], v[24:27], 0
    v_mov_b32_dpp v17, v48 quad_perm:[0,1,2,3] row_mask:0xf bank_mask:0x1
    v_add_f32_dpp v17, v49, v17 row_ror:12 row_mask:0xf bank_mask:0x1
    v_add_f32_dpp v17, v50, v17 row_ror:8 row_mask:0xf bank_mask:0x1
    v_add_f32_dpp v17, v51, v17 row_ror:4 row_mask:0xf bank_mask:0x1
    v_mov_b32_dpp v17, v52 row_ror:4 row_mask:0xf bank_mask:0x2
    v_add_f32_dpp v17, v53, v17 quad_perm:[0,1,2,3] row_mask:0xf bank_mask:0x2
    v_add_f32_dpp v17, v54, v17 row_ror:12 row_mask:0xf bank_mask:0x2
    v_add_f32_dpp v17, v55, v17 row_ror:8 row_mask:0xf bank_mask:0x2
    v_mov_b32_dpp v17, v56 row_ror:8 row_mask:0xf bank_mask:0x4
    v_add_f32_dpp v17, v57, v17 row_ror:4 row_mask:0xf bank_mask:0x4
    v_add_f32_dpp v17, v58, v17 quad_perm:[0,1,2,3] row_mask:0xf bank_mask:0x4
    v_add_f32_dpp v17, v59, v17 row_ror:12 row_mask:0xf bank_mask:0x4
    v_mov_b32_dpp v17, v60 row_ror:12 row_mask:0xf bank_mask:0x8
    v_add_f32_dpp v17, v61, v17 row_ror:8 row_mask:0xf bank_mask:0x8
    v_add_f32_dpp v17, v62, v17 row_ror:4 row_mask:0xf bank_mask:0x8
    v_add_f32_dpp v17, v63, v17 quad_perm:[0,1,2,3] row_mask:0xf bank_mask:0x8
    v_mfma_f32_16x16x32_bf16 v[48:51], v[176:179], v[24:27], 0
    v_mfma_f32_16x16x32_bf16 v[52:55], v[180:183], v[24:27], 0
    v_mfma_f32_16x16x32_bf16 v[56:59], v[184:187], v[24:27], 0
    v_mfma_f32_16x16x32_bf16 v[60:63], v[188:191], v[24:27], 0
    v_mov_b32_dpp v18, v32 quad_perm:[0,1,2,3] row_mask:0xf bank_mask:0x1
    v_add_f32_dpp v18, v33, v18 row_ror:12 row_mask:0xf bank_mask:0x1
    v_add_f32_dpp v18, v34, v18 row_ror:8 row_mask:0xf bank_mask:0x1
    v_add_f32_dpp v18, v35, v18 row_ror:4 row_mask:0xf bank_mask:0x1
    v_mov_b32_dpp v18, v36 row_ror:4 row_mask:0xf bank_mask:0x2
    v_add_f32_dpp v18, v37, v18 quad_perm:[0,1,2,3] row_mask:0xf bank_mask:0x2
    v_add_f32_dpp v18, v38, v18 row_ror:12 row_mask:0xf bank_mask:0x2
    v_add_f32_dpp v18, v39, v18 row_ror:8 row_mask:0xf bank_mask:0x2
    v_mov_b32_dpp v18, v40 row_ror:8 row_mask:0xf bank_mask:0x4
    v_add_f32_dpp v18, v41, v18 row_ror:4 row_mask:0xf bank_mask:0x4
    v_add_f32_dpp v18, v42, v18 quad_perm:[0,1,2,3] row_mask:0xf bank_mask:0x4
    v_add_f32_dpp v18, v43, v18 row_ror:12 row_mask:0xf bank_mask:0x4
    v_mov_b32_dpp v18, v44 row_ror:12 row_mask:0xf bank_mask:0x8
    v_add_f32_dpp v18, v45, v18 row_ror:8 row_mask:0xf bank_mask:0x8
    v_add_f32_dpp v18, v46, v18 row_ror:4 row_mask:0xf bank_mask:0x8
    v_add_f32_dpp v18, v47, v18 quad_perm:[0,1,2,3] row_mask:0xf bank_mask:0x8
    v_mfma_f32_16x16x32_bf16 v[32:35], v[192:195], v[24:27], 0
    v_mfma_f32_16x16x32_bf16 v[36:39], v[196:199], v[24:27], 0
    v_mfma_f32_16x16x32_bf16 v[40:43], v[200:203], v[24:27], 0
    v_mfma_f32_16x16x32_bf16 v[44:47], v[204:207], v[24:27], 0
    v_mov_b32_dpp v19, v48 quad_perm:[0,1,2,3] row_mask:0xf bank_mask:0x1
    v_add_f32_dpp v19, v49, v19 row_ror:12 row_mask:0xf bank_mask:0x1
    v_add_f32_dpp v19, v50, v19 row_ror:8 row_mask:0xf bank_mask:0x1
    v_add_f32_dpp v19, v51, v19 row_ror:4 row_mask:0xf bank_mask:0x1
    v_mov_b32_dpp v19, v52 row_ror:4 row_mask:0xf bank_mask:0x2
    v_add_f32_dpp v19, v53, v19 quad_perm:[0,1,2,3] row_mask:0xf bank_mask:0x2
    v_add_f32_dpp v19, v54, v19 row_ror:12 row_mask:0xf bank_mask:0x2
    v_add_f32_dpp v19, v55, v19 row_ror:8 row_mask:0xf bank_mask:0x2
    v_mov_b32_dpp v19, v56 row_ror:8 row_mask:0xf bank_mask:0x4
    v_add_f32_dpp v19, v57, v19 row_ror:4 row_mask:0xf bank_mask:0x4
    v_add_f32_dpp v19, v58, v19 quad_perm:[0,1,2,3] row_mask:0xf bank_mask:0x4
    v_add_f32_dpp v19, v59, v19 row_ror:12 row_mask:0xf bank_mask:0x4
    v_mov_b32_dpp v19, v60 row_ror:12 row_mask:0xf bank_mask:0x8
    v_add_f32_dpp v19, v61, v19 row_ror:8 row_mask:0xf bank_mask:0x8
    v_add_f32_dpp v19, v62, v19 row_ror:4 row_mask:0xf bank_mask:0x8
    v_add_f32_dpp v19, v63, v19 quad_perm:[0,1,2,3] row_mask:0xf bank_mask:0x8
    v_mfma_f32_16x16x32_bf16 v[48:51], v[208:211], v[24:27], 0
    v_mfma_f32_16x16x32_bf16 v[52:55], v[212:215], v[24:27], 0
    v_mfma_f32_16x16x32_bf16 v[56:59], v[216:219], v[24:27], 0
    v_mfma_f32_16x16x32_bf16 v[60:63], v[220:223], v[24:27], 0
    v_mov_b32_dpp v20, v32 quad_perm:[0,1,2,3] row_mask:0xf bank_mask:0x1
    v_add_f32_dpp v20, v33, v20 row_ror:12 row_mask:0xf bank_mask:0x1
    v_add_f32_dpp v20, v34, v20 row_ror:8 row_mask:0xf bank_mask:0x1
    v_add_f32_dpp v20, v35, v20 row_ror:4 row_mask:0xf bank_mask:0x1
    v_mov_b32_dpp v20, v36 row_ror:4 row_mask:0xf bank_mask:0x2
    v_add_f32_dpp v20, v37, v20 quad_perm:[0,1,2,3] row_mask:0xf bank_mask:0x2
    v_add_f32_dpp v20, v38, v20 row_ror:12 row_mask:0xf bank_mask:0x2
    v_add_f32_dpp v20, v39, v20 row_ror:8 row_mask:0xf bank_mask:0x2
    v_mov_b32_dpp v20, v40 row_ror:8 row_mask:0xf bank_mask:0x4
    v_add_f32_dpp v20, v41, v20 row_ror:4 row_mask:0xf bank_mask:0x4
    v_add_f32_dpp v20, v42, v20 quad_perm:[0,1,2,3] row_mask:0xf bank_mask:0x4
    v_add_f32_dpp v20, v43, v20 row_ror:12 row_mask:0xf bank_mask:0x4
    v_mov_b32_dpp v20, v44 row_ror:12 row_mask:0xf bank_mask:0x8
    v_add_f32_dpp v20, v45, v20 row_ror:8 row_mask:0xf bank_mask:0x8
    v_add_f32_dpp v20, v46, v20 row_ror:4 row_mask:0xf bank_mask:0x8
    v_add_f32_dpp v20, v47, v20 quad_perm:[0,1,2,3] row_mask:0xf bank_mask:0x8
    v_mfma_f32_16x16x32_bf16 v[32:35], v[224:227], v[24:27], 0
    v_mfma_f32_16x16x32_bf16 v[36:39], v[228:231], v[24:27], 0
    v_mfma_f32_16x16x32_bf16 v[40:43], v[232:235], v[24:27], 0
    v_mfma_f32_16x16x32_bf16 v[44:47], v[236:239], v[24:27], 0
    v_mov_b32_dpp v21, v48 quad_perm:[0,1,2,3] row_mask:0xf bank_mask:0x1
    v_add_f32_dpp v21, v49, v21 row_ror:12 row_mask:0xf bank_mask:0x1
    v_add_f32_dpp v21, v50, v21 row_ror:8 row_mask:0xf bank_mask:0x1
    v_add_f32_dpp v21, v51, v21 row_ror:4 row_mask:0xf bank_mask:0x1
    v_mov_b32_dpp v21, v52 row_ror:4 row_mask:0xf bank_mask:0x2
    v_add_f32_dpp v21, v53, v21 quad_perm:[0,1,2,3] row_mask:0xf bank_mask:0x2
    v_add_f32_dpp v21, v54, v21 row_ror:12 row_mask:0xf bank_mask:0x2
    v_add_f32_dpp v21, v55, v21 row_ror:8 row_mask:0xf bank_mask:0x2
    v_mov_b32_dpp v21, v56 row_ror:8 row_mask:0xf bank_mask:0x4
    v_add_f32_dpp v21, v57, v21 row_ror:4 row_mask:0xf bank_mask:0x4
    v_add_f32_dpp v21, v58, v21 quad_perm:[0,1,2,3] row_mask:0xf bank_mask:0x4
    v_add_f32_dpp v21, v59, v21 row_ror:12 row_mask:0xf bank_mask:0x4
    v_mov_b32_dpp v21, v60 row_ror:12 row_mask:0xf bank_mask:0x8
    v_add_f32_dpp v21, v61, v21 row_ror:8 row_mask:0xf bank_mask:0x8
    v_add_f32_dpp v21, v62, v21 row_ror:4 row_mask:0xf bank_mask:0x8
    v_add_f32_dpp v21, v63, v21 quad_perm:[0,1,2,3] row_mask:0xf bank_mask:0x8
    v_mfma_f32_16x16x32_bf16 v[48:51], v[240:243], v[24:27], 0
    v_mfma_f32_16x16x32_bf16 v[52:55], v[244:247], v[24:27], 0
    v_mfma_f32_16x16x32_bf16 v[56:59], v[248:251], v[24:27], 0
    v_mfma_f32_16x16x32_bf16 v[60:63], v[252:255], v[24:27], 0
    v_mov_b32_dpp v22, v32 quad_perm:[0,1,2,3] row_mask:0xf bank_mask:0x1
    v_add_f32_dpp v22, v33, v22 row_ror:12 row_mask:0xf bank_mask:0x1
    v_add_f32_dpp v22, v34, v22 row_ror:8 row_mask:0xf bank_mask:0x1
    v_add_f32_dpp v22, v35, v22 row_ror:4 row_mask:0xf bank_mask:0x1
    v_mov_b32_dpp v22, v36 row_ror:4 row_mask:0xf bank_mask:0x2
    v_add_f32_dpp v22, v37, v22 quad_perm:[0,1,2,3] row_mask:0xf bank_mask:0x2
    v_add_f32_dpp v22, v38, v22 row_ror:12 row_mask:0xf bank_mask:0x2
    v_add_f32_dpp v22, v39, v22 row_ror:8 row_mask:0xf bank_mask:0x2
    v_mov_b32_dpp v22, v40 row_ror:8 row_mask:0xf bank_mask:0x4
    v_add_f32_dpp v22, v41, v22 row_ror:4 row_mask:0xf bank_mask:0x4
    v_add_f32_dpp v22, v42, v22 quad_perm:[0,1,2,3] row_mask:0xf bank_mask:0x4
    v_add_f32_dpp v22, v43, v22 row_ror:12 row_mask:0xf bank_mask:0x4
    v_mov_b32_dpp v22, v44 row_ror:12 row_mask:0xf bank_mask:0x8
    v_add_f32_dpp v22, v45, v22 row_ror:8 row_mask:0xf bank_mask:0x8
    v_add_f32_dpp v22, v46, v22 row_ror:4 row_mask:0xf bank_mask:0x8
    v_add_f32_dpp v22, v47, v22 quad_perm:[0,1,2,3] row_mask:0xf bank_mask:0x8
    v_mov_b32_dpp v23, v48 quad_perm:[0,1,2,3] row_mask:0xf bank_mask:0x1
    v_add_f32_dpp v23, v49, v23 row_ror:12 row_mask:0xf bank_mask:0x1
    v_add_f32_dpp v23, v50, v23 row_ror:8 row_mask:0xf bank_mask:0x1
    v_add_f32_dpp v23, v51, v23 row_ror:4 row_mask:0xf bank_mask:0x1
    v_mov_b32_dpp v23, v52 row_ror:4 row_mask:0xf bank_mask:0x2
    v_add_f32_dpp v23, v53, v23 quad_perm:[0,1,2,3] row_mask:0xf bank_mask:0x2
    v_add_f32_dpp v23, v54, v23 row_ror:12 row_mask:0xf bank_mask:0x2
    v_add_f32_dpp v23, v55, v23 row_ror:8 row_mask:0xf bank_mask:0x2
    v_mov_b32_dpp v23, v56 row_ror:8 row_mask:0xf bank_mask:0x4
    v_add_f32_dpp v23, v57, v23 row_ror:4 row_mask:0xf bank_mask:0x4
    v_add_f32_dpp v23, v58, v23 quad_perm:[0,1,2,3] row_mask:0xf bank_mask:0x4
    v_add_f32_dpp v23, v59, v23 row_ror:12 row_mask:0xf bank_mask:0x4
    v_mov_b32_dpp v23, v60 row_ror:12 row_mask:0xf bank_mask:0x8
    v_add_f32_dpp v23, v61, v23 row_ror:8 row_mask:0xf bank_mask:0x8
    v_add_f32_dpp v23, v62, v23 row_ror:4 row_mask:0xf bank_mask:0x8
    v_add_f32_dpp v23, v63, v23 quad_perm:[0,1,2,3] row_mask:0xf bank_mask:0x8
    v_cvt_pk_bf16_f32 v24, v16, v17
    v_cvt_pk_bf16_f32 v25, v18, v19
    v_cvt_pk_bf16_f32 v26, v20, v21
    v_cvt_pk_bf16_f32 v27, v22, v23
    v_lshlrev_b32 v16, 16, v24
    v_and_b32 v17, 0xffff0000, v24
    v_lshlrev_b32 v18, 16, v25
    v_and_b32 v19, 0xffff0000, v25
    v_lshlrev_b32 v20, 16, v26
    v_and_b32 v21, 0xffff0000, v26
    v_lshlrev_b32 v22, 16, v27
    v_and_b32 v23, 0xffff0000, v27
    v_mul_f32 v16, s57, v16
    v_mul_f32 v17, s57, v17
    v_mul_f32 v18, s57, v18
    v_mul_f32 v19, s57, v19
    v_mul_f32 v20, s57, v20
    v_mul_f32 v21, s57, v21
    v_mul_f32 v22, s57, v22
    v_mul_f32 v23, s57, v23
    v_cvt_pk_bf16_f32 v24, v16, v17
    v_cvt_pk_bf16_f32 v25, v18, v19
    v_cvt_pk_bf16_f32 v26, v20, v21
    v_cvt_pk_bf16_f32 v27, v22, v23
    v_lshlrev_b32 v16, 16, v24
    v_and_b32 v17, 0xffff0000, v24
    v_lshlrev_b32 v18, 16, v25
    v_and_b32 v19, 0xffff0000, v25
    v_lshlrev_b32 v20, 16, v26
    v_and_b32 v21, 0xffff0000, v26
    v_lshlrev_b32 v22, 16, v27
    v_and_b32 v23, 0xffff0000, v27
    v_max3_f32 v28, v16, v17, v18
    v_max3_f32 v25, v19, v20, v21
    v_max3_f32 v28, v28, v22, v23
    v_max_f32 v28, v28, v25
    s_nop 1
    v_max_f32_dpp v28, v28, v28 row_ror:4 row_mask:0xf bank_mask:0xf
    s_nop 1
    v_max_f32_dpp v28, v28, v28 row_ror:8 row_mask:0xf bank_mask:0xf
    v_mov_b32 v26, v28
    s_nop 1
    v_permlane16_swap_b32 v28, v26
    v_max_f32 v28, v28, v26
    v_mov_b32 v26, v28
    s_nop 1
    v_permlane32_swap_b32 v28, v26
    v_max_f32 v28, v28, v26
    v_sub_f32 v16, v16, v28
    v_sub_f32 v17, v17, v28
    v_sub_f32 v18, v18, v28
    v_sub_f32 v19, v19, v28
    v_sub_f32 v20, v20, v28
    v_sub_f32 v21, v21, v28
    v_sub_f32 v22, v22, v28
    v_sub_f32 v23, v23, v28
    v_mul_f32 v16, s69, v16
    v_mul_f32 v17, s69, v17
    v_mul_f32 v18, s69, v18
    v_mul_f32 v19, s69, v19
    v_mul_f32 v20, s69, v20
    v_mul_f32 v21, s69, v21
    v_mul_f32 v22, s69, v22
    v_mul_f32 v23, s69, v23
    v_exp_f32 v16, v16
    v_exp_f32 v17, v17
    v_exp_f32 v18, v18
    v_exp_f32 v19, v19
    v_exp_f32 v20, v20
    v_exp_f32 v21, v21
    v_exp_f32 v22, v22
    v_exp_f32 v23, v23
    v_cvt_pk_bf16_f32 v32, v16, v17
    v_cvt_pk_bf16_f32 v33, v18, v19
    v_cvt_pk_bf16_f32 v34, v20, v21
    v_cvt_pk_bf16_f32 v35, v22, v23
    v_lshl_add_u32 v10, v7, 2, v1
    v_mul_u32_u24 v10, 80, v10
    v_lshl_add_u32 v10, v6, 4, v10
    s_mul_i32 s56, s3, 1280
    v_add_u32 v10, s56, v10
    ds_write_b128 v10, v[32:35] offset:5504
    v_add_f32 v16, v16, v17
    v_add_f32 v18, v18, v19
    v_add_f32 v20, v20, v21
    v_add_f32 v22, v22, v23
    v_add_f32 v16, v16, v18
    v_add_f32 v20, v20, v22
    v_add_f32 v29, v16, v20
    s_lshl_b32 s56, s3, 2
    s_add_u32 s56, s56, 22560
    v_mov_b32 v9, s56
    s_mov_b64 exec, 1
    ds_write_b32 v9, v14
    s_mov_b64 exec, -1
    v_add_f32_dpp v29, v29, v29 row_ror:4 row_mask:0xf bank_mask:0xf
    s_nop 1
    v_add_f32_dpp v29, v29, v29 row_ror:8 row_mask:0xf bank_mask:0xf
    v_mov_b32 v26, v29
    s_nop 1
    v_permlane16_swap_b32 v29, v26
    v_add_f32 v29, v29, v26
    v_mov_b32 v26, v29
    s_nop 1
    v_permlane32_swap_b32 v29, v26
    v_add_f32 v29, v29, v26
    v_mov_b32 v30, 1
    v_mov_b32 v31, 0
    v_lshlrev_b32 v8, 6, v7
    s_lshl_b32 s56, s3, 4
    v_add_u32 v8, s56, v8
    s_mov_b64 exec, 0xf
    ds_write_b128 v8, v[28:31] offset:22144
    s_mov_b64 exec, -1
    s_cmp_eq_u32 s3, 2
    s_cbranch_scc1 L_k2b
    s_cmp_lg_u32 s3, 1
    s_cbranch_scc1 L_kfac
    s_lshr_b32 s56, s2, 3
    s_mul_i32 s57, s56, 57344
    s_and_b32 s58, s2, 7
    s_lshl_b32 s60, s58, 7
    s_add_u32 s57, s57, s60
    s_add_u32 s8, s32, s57
    s_addc_u32 s9, s33, 0
    s_and_b32 s9, s9, 0xffff
    s_sub_u32 s10, 1835008, s57
    s_mov_b32 s11, 0x20000
    s_movk_i32 s60, 1024
    v_lshrrev_b32 v6, 3, v0
    v_and_b32 v10, 7, v0
    v_and_b32 v11, 2, v6
    v_xor_b32 v10, v10, v11
    v_xor_b32 v11, 4, v10
    v_mul_lo_u32 v6, v6, s60
    v_lshl_add_u32 v10, v10, 4, v6
    v_lshl_add_u32 v11, v11, 4, v6
    v_mov_b32 v16, 0
    v_mov_b32 v17, 0
    v_mov_b32 v18, 0
    v_mov_b32 v19, 0
    ds_write_b128 v84, v[16:19] offset:31744
    v_lshrrev_b32 v6, 3, v0
    v_and_b32 v7, 7, v0
    s_mul_i32 s57, s56, 14
    v_add_u32 v20, s57, v7
    v_min_u32 v21, 5, v7
    v_add_u32 v21, s57, v21
    v_add_u32 v21, 8, v21
    v_lshrrev_b32 v8, 2, v20
    v_and_b32 v20, 3, v20
    v_lshlrev_b32 v20, 4, v20
    v_lshl_add_u32 v20, v8, 9, v20
    v_lshl_add_u32 v20, v6, 6, v20
    v_lshrrev_b32 v8, 2, v21
    v_and_b32 v21, 3, v21
    v_lshlrev_b32 v21, 4, v21
    v_lshl_add_u32 v21, v8, 9, v21
    v_lshl_add_u32 v21, v6, 6, v21
    s_mov_b32 s60, 196608
    s_mov_b32 s61, 442368
    s_mov_b32 s62, 253952
    s_mov_b32 s63, 499712
    s_mov_b32 s96, 400000
cr_13:
    ds_read_b32 v8, v15 offset:22576
    s_waitcnt lgkmcnt(0)
    v_readfirstlane_b32 s97, v8
    s_cmp_ge_i32 s97, 33
    s_cbranch_scc1 crd_14
    s_sleep 4
    s_sub_u32 s96, s96, 1
    s_cbranch_scc0 cr_13
crd_14:
    s_mov_b32 s96, 400000
cr_15:
    ds_read_b32 v8, v15 offset:22576
    s_waitcnt lgkmcnt(0)
    v_readfirstlane_b32 s97, v8
    s_cmp_ge_i32 s97, 35
    s_cbranch_scc1 crd_16
    s_sleep 1
    s_sub_u32 s96, s96, 1
    s_cbranch_scc0 cr_15
crd_16:
    buffer_load_dwordx4 v[24:27], v20, s[48:51], s60 offen sc1
    buffer_load_dwordx4 v[28:31], v20, s[48:51], s61 offen sc1
    buffer_load_dwordx4 v[32:35], v20, s[48:51], s62 offen sc1
    buffer_load_dwordx4 v[36:39], v20, s[48:51], s63 offen sc1
    buffer_load_dwordx4 v[40:43], v21, s[48:51], s60 offen sc1
    buffer_load_dwordx4 v[44:47], v21, s[48:51], s61 offen sc1
    buffer_load_dwordx4 v[48:51], v21, s[48:51], s62 offen sc1
    buffer_load_dwordx4 v[52:55], v21, s[48:51], s63 offen sc1
    s_mov_b32 s96, 400000
cr_17:
    ds_read_b32 v8, v15 offset:22576
    s_waitcnt lgkmcnt(0)
    v_readfirstlane_b32 s97, v8
    s_cmp_ge_i32 s97, 36
    s_cbranch_scc1 crd_18
    s_sleep 1
    s_sub_u32 s96, s96, 1
    s_cbranch_scc0 cr_17
crd_18:
    s_mov_b32 m0, 24576
    s_mov_b32 s64, 0
    buffer_load_dwordx4 v10, s[8:11], s64 offen offset:0 nt lds
    s_mov_b32 s64, 7168
    buffer_load_dwordx4 v11, s[8:11], s64 offen offset:1024 nt lds
    s_mov_b32 s64, 14336
    buffer_load_dwordx4 v10, s[8:11], s64 offen offset:2048 nt lds
    s_mov_b32 s64, 21504
    buffer_load_dwordx4 v11, s[8:11], s64 offen offset:3072 nt lds
    s_mov_b32 m0, 28672
    s_mov_b32 s64, 32768
    buffer_load_dwordx4 v10, s[8:11], s64 offen offset:0 nt lds
    s_mov_b32 s64, 39936
    buffer_load_dwordx4 v11, s[8:11], s64 offen offset:1024 nt lds
    s_mov_b32 s64, 47104
    buffer_load_dwordx4 v10, s[8:11], s64 offen offset:2048 nt lds
    s_waitcnt vmcnt(14)
    v_msad_u8 v8, v24, s41, 0
    v_msad_u8 v8, v25, s42, v8
    v_msad_u8 v8, v26, s43, v8
    v_msad_u8 v8, v27, s44, v8
    s_waitcnt vmcnt(13)
    v_msad_u8 v8, v28, s41, v8
    v_msad_u8 v8, v29, s42, v8
    v_msad_u8 v8, v30, s43, v8
    v_msad_u8 v8, v31, s44, v8
    s_waitcnt vmcnt(12)
    v_msad_u8 v8, v32, s41, v8
    v_msad_u8 v8, v33, s42, v8
    v_msad_u8 v8, v34, s43, v8
    v_msad_u8 v8, v35, s44, v8
    s_waitcnt vmcnt(11)
    v_msad_u8 v8, v36, s41, v8
    v_msad_u8 v8, v37, s42, v8
    v_msad_u8 v8, v38, s43, v8
    v_msad_u8 v8, v39, s44, v8
    s_waitcnt vmcnt(10)
    v_msad_u8 v8, v40, s41, v8
    v_msad_u8 v8, v41, s42, v8
    v_msad_u8 v8, v42, s43, v8
    v_msad_u8 v8, v43, s44, v8
    s_waitcnt vmcnt(9)
    v_msad_u8 v8, v44, s41, v8
    v_msad_u8 v8, v45, s42, v8
    v_msad_u8 v8, v46, s43, v8
    v_msad_u8 v8, v47, s44, v8
    s_waitcnt vmcnt(8)
    v_msad_u8 v8, v48, s41, v8
    v_msad_u8 v8, v49, s42, v8
    v_msad_u8 v8, v50, s43, v8
    v_msad_u8 v8, v51, s44, v8
    s_waitcnt vmcnt(7)
    v_msad_u8 v8, v52, s41, v8
    v_msad_u8 v8, v53, s42, v8
    v_msad_u8 v8, v54, s43, v8
    v_msad_u8 v8, v55, s44, v8
    v_cmp_ne_u32 vcc, 0, v8
    s_cbranch_vccz L_guok
    s_mov_b32 s96, 40000
poll_19:
    buffer_load_dwordx4 v[24:27], v20, s[48:51], s60 offen sc1
    buffer_load_dwordx4 v[28:31], v20, s[48:51], s61 offen sc1
    buffer_load_dwordx4 v[32:35], v20, s[48:51], s62 offen sc1
    buffer_load_dwordx4 v[36:39], v20, s[48:51], s63 offen sc1
    buffer_load_dwordx4 v[40:43], v21, s[48:51], s60 offen sc1
    buffer_load_dwordx4 v[44:47], v21, s[48:51], s61 offen sc1
    buffer_load_dwordx4 v[48:51], v21, s[48:51], s62 offen sc1
    buffer_load_dwordx4 v[52:55], v21, s[48:51], s63 offen sc1
    s_waitcnt vmcnt(7)
    v_msad_u8 v8, v24, s41, 0
    v_msad_u8 v8, v25, s42, v8
    v_msad_u8 v8, v26, s43, v8
    v_msad_u8 v8, v27, s44, v8
    s_waitcnt vmcnt(6)
    v_msad_u8 v8, v28, s41, v8
    v_msad_u8 v8, v29, s42, v8
    v_msad_u8 v8, v30, s43, v8
    v_msad_u8 v8, v31, s44, v8
    s_waitcnt vmcnt(5)
    v_msad_u8 v8, v32, s41, v8
    v_msad_u8 v8, v33, s42, v8
    v_msad_u8 v8, v34, s43, v8
    v_msad_u8 v8, v35, s44, v8
    s_waitcnt vmcnt(4)
    v_msad_u8 v8, v36, s41, v8
    v_msad_u8 v8, v37, s42, v8
    v_msad_u8 v8, v38, s43, v8
    v_msad_u8 v8, v39, s44, v8
    s_waitcnt vmcnt(3)
    v_msad_u8 v8, v40, s41, v8
    v_msad_u8 v8, v41, s42, v8
    v_msad_u8 v8, v42, s43, v8
    v_msad_u8 v8, v43, s44, v8
    s_waitcnt vmcnt(2)
    v_msad_u8 v8, v44, s41, v8
    v_msad_u8 v8, v45, s42, v8
    v_msad_u8 v8, v46, s43, v8
    v_msad_u8 v8, v47, s44, v8
    s_waitcnt vmcnt(1)
    v_msad_u8 v8, v48, s41, v8
    v_msad_u8 v8, v49, s42, v8
    v_msad_u8 v8, v50, s43, v8
    v_msad_u8 v8, v51, s44, v8
    s_waitcnt vmcnt(0)
    v_msad_u8 v8, v52, s41, v8
    v_msad_u8 v8, v53, s42, v8
    v_msad_u8 v8, v54, s43, v8
    v_msad_u8 v8, v55, s44, v8
    v_cmp_ne_u32 vcc, 0, v8
    s_cbranch_vccz polld_20
    s_sleep 2
    s_sub_u32 s96, s96, 1
    s_cbranch_scc0 poll_19
polld_20:
L_guok:
    v_add_f32 v24, v24, v28
    v_add_f32 v32, v32, v36
    v_add_f32 v25, v25, v29
    v_add_f32 v33, v33, v37
    v_add_f32 v26, v26, v30
    v_add_f32 v34, v34, v38
    v_add_f32 v27, v27, v31
    v_add_f32 v35, v35, v39
    v_add_f32 v40, v40, v44
    v_add_f32 v48, v48, v52
    v_add_f32 v41, v41, v45
    v_add_f32 v49, v49, v53
    v_add_f32 v42, v42, v46
    v_add_f32 v50, v50, v54
    v_add_f32 v43, v43, v47
    v_add_f32 v51, v51, v55
    v_cvt_pk_bf16_f32 v24, v24, v24
    v_cvt_pk_bf16_f32 v25, v25, v25
    v_cvt_pk_bf16_f32 v26, v26, v26
    v_cvt_pk_bf16_f32 v27, v27, v27
    v_cvt_pk_bf16_f32 v40, v40, v40
    v_cvt_pk_bf16_f32 v41, v41, v41
    v_cvt_pk_bf16_f32 v42, v42, v42
    v_cvt_pk_bf16_f32 v43, v43, v43
    v_cvt_pk_bf16_f32 v32, v32, v32
    v_cvt_pk_bf16_f32 v33, v33, v33
    v_cvt_pk_bf16_f32 v34, v34, v34
    v_cvt_pk_bf16_f32 v35, v35, v35
    v_cvt_pk_bf16_f32 v48, v48, v48
    v_cvt_pk_bf16_f32 v49, v49, v49
    v_cvt_pk_bf16_f32 v50, v50, v50
    v_cvt_pk_bf16_f32 v51, v51, v51
    v_lshlrev_b32 v24, 16, v24
    v_lshlrev_b32 v25, 16, v25
    v_lshlrev_b32 v26, 16, v26
    v_lshlrev_b32 v27, 16, v27
    v_lshlrev_b32 v40, 16, v40
    v_lshlrev_b32 v41, 16, v41
    v_lshlrev_b32 v42, 16, v42
    v_lshlrev_b32 v43, 16, v43
    v_lshlrev_b32 v32, 16, v32
    v_lshlrev_b32 v33, 16, v33
    v_lshlrev_b32 v34, 16, v34
    v_lshlrev_b32 v35, 16, v35
    v_lshlrev_b32 v48, 16, v48
    v_lshlrev_b32 v49, 16, v49
    v_lshlrev_b32 v50, 16, v50
    v_lshlrev_b32 v51, 16, v51
    s_mov_b32 s57, 3216550459
    v_mul_f32 v24, s57, v24
    v_mul_f32 v25, s57, v25
    v_mul_f32 v26, s57, v26
    v_mul_f32 v27, s57, v27
    v_mul_f32 v40, s57, v40
    v_mul_f32 v41, s57, v41
    v_mul_f32 v42, s57, v42
    v_mul_f32 v43, s57, v43
    v_exp_f32 v24, v24
    v_exp_f32 v25, v25
    v_exp_f32 v26, v26
    v_exp_f32 v27, v27
    v_exp_f32 v40, v40
    v_exp_f32 v41, v41
    v_exp_f32 v42, v42
    v_exp_f32 v43, v43
    v_add_f32 v24, 1.0, v24
    v_add_f32 v25, 1.0, v25
    v_add_f32 v26, 1.0, v26
    v_add_f32 v27, 1.0, v27
    v_add_f32 v40, 1.0, v40
    v_add_f32 v41, 1.0, v41
    v_add_f32 v42, 1.0, v42
    v_add_f32 v43, 1.0, v43
    v_rcp_f32 v24, v24
    v_rcp_f32 v25, v25
    v_rcp_f32 v26, v26
    v_rcp_f32 v27, v27
    v_rcp_f32 v40, v40
    v_rcp_f32 v41, v41
    v_rcp_f32 v42, v42
    v_rcp_f32 v43, v43
    v_cvt_pk_bf16_f32 v24, v24, v24
    v_cvt_pk_bf16_f32 v25, v25, v25
    v_cvt_pk_bf16_f32 v26, v26, v26
    v_cvt_pk_bf16_f32 v27, v27, v27
    v_cvt_pk_bf16_f32 v40, v40, v40
    v_cvt_pk_bf16_f32 v41, v41, v41
    v_cvt_pk_bf16_f32 v42, v42, v42
    v_cvt_pk_bf16_f32 v43, v43, v43
    v_lshlrev_b32 v24, 16, v24
    v_lshlrev_b32 v25, 16, v25
    v_lshlrev_b32 v26, 16, v26
    v_lshlrev_b32 v27, 16, v27
    v_lshlrev_b32 v40, 16, v40
    v_lshlrev_b32 v41, 16, v41
    v_lshlrev_b32 v42, 16, v42
    v_lshlrev_b32 v43, 16, v43
    v_mul_f32 v24, v24, v32
    v_mul_f32 v25, v25, v33
    v_mul_f32 v26, v26, v34
    v_mul_f32 v27, v27, v35
    v_mul_f32 v40, v40, v48
    v_mul_f32 v41, v41, v49
    v_mul_f32 v42, v42, v50
    v_mul_f32 v43, v43, v51
    v_cvt_pk_bf16_f32 v28, v24, v25
    v_cvt_pk_bf16_f32 v29, v26, v27
    v_cvt_pk_bf16_f32 v30, v40, v41
    v_cvt_pk_bf16_f32 v31, v42, v43
    v_cmp_gt_u32 vcc, 6, v7
    v_mul_u32_u24 v8, 144, v6
    v_lshl_add_u32 v8, v7, 3, v8
    v_cndmask_b32 v30, 0, v30, vcc
    v_cndmask_b32 v31, 0, v31, vcc
    ds_write_b64 v8, v[28:29] offset:20992
    ds_write_b64 v8, v[30:31] offset:21056
    v_and_b32 v8, 7, v2
    v_mul_u32_u24 v8, 144, v8
    v_lshl_add_u32 v8, v1, 4, v8
    ds_read_b128 v[24:27], v8 offset:20992
    ds_read_b128 v[28:31], v8 offset:21056
    s_waitcnt vmcnt(0)
    v_xor_b32 v9, 0, v88
    ds_read_b64_tr_b16 v[128:129], v9 offset:24576
    ds_read_b64_tr_b16 v[130:131], v9 offset:25088
    ds_read_b64_tr_b16 v[132:133], v9 offset:28672
    ds_read_b64_tr_b16 v[134:135], v9 offset:29184
    v_xor_b32 v9, 32, v88
    ds_read_b64_tr_b16 v[144:145], v9 offset:24576
    ds_read_b64_tr_b16 v[146:147], v9 offset:25088
    ds_read_b64_tr_b16 v[148:149], v9 offset:28672
    ds_read_b64_tr_b16 v[150:151], v9 offset:29184
    v_xor_b32 v9, 64, v88
    ds_read_b64_tr_b16 v[160:161], v9 offset:24576
    ds_read_b64_tr_b16 v[162:163], v9 offset:25088
    ds_read_b64_tr_b16 v[164:165], v9 offset:28672
    ds_read_b64_tr_b16 v[166:167], v9 offset:29184
    v_xor_b32 v9, 96, v88
    ds_read_b64_tr_b16 v[176:177], v9 offset:24576
    ds_read_b64_tr_b16 v[178:179], v9 offset:25088
    ds_read_b64_tr_b16 v[180:181], v9 offset:28672
    ds_read_b64_tr_b16 v[182:183], v9 offset:29184
    s_lshl_b32 s57, s58, 16
    s_lshl_b32 s60, s56, 11
    s_add_u32 s57, s57, s60
    s_add_u32 s60, s57, 1703936
    s_mov_b32 s66, 0x00ff00ff
    s_mov_b32 s67, 0x00ff00ff
    s_waitcnt lgkmcnt(0)
    v_mfma_f32_16x16x32_bf16 v[32:35], v[128:131], v[24:27], 0
    v_mfma_f32_16x16x32_bf16 v[36:39], v[144:147], v[24:27], 0
    v_mfma_f32_16x16x32_bf16 v[40:43], v[160:163], v[24:27], 0
    v_mfma_f32_16x16x32_bf16 v[44:47], v[176:179], v[24:27], 0
    v_mfma_f32_16x16x32_bf16 v[32:35], v[132:135], v[28:31], v[32:35]
    v_mfma_f32_16x16x32_bf16 v[36:39], v[148:151], v[28:31], v[36:39]
    v_mfma_f32_16x16x32_bf16 v[40:43], v[164:167], v[28:31], v[40:43]
    v_mfma_f32_16x16x32_bf16 v[44:47], v[180:183], v[28:31], v[44:47]
    s_nop 4
    v_bfi_b32 v32, v3, s41, v32
    v_bfi_b32 v33, v3, s42, v33
    v_bfi_b32 v34, v3, s43, v34
    v_bfi_b32 v35, v3, s44, v35
    v_bfi_b32 v36, v3, s41, v36
    v_bfi_b32 v37, v3, s42, v37
    v_bfi_b32 v38, v3, s43, v38
    v_bfi_b32 v39, v3, s44, v39
    v_bfi_b32 v40, v3, s41, v40
    v_bfi_b32 v41, v3, s42, v41
    v_bfi_b32 v42, v3, s43, v42
    v_bfi_b32 v43, v3, s44, v43
    v_bfi_b32 v44, v3, s41, v44
    v_bfi_b32 v45, v3, s42, v45
    v_bfi_b32 v46, v3, s43, v46
    v_bfi_b32 v47, v3, s44, v47
    s_mov_b64 exec, s[66:67]
    buffer_store_dwordx4 v[32:35], v89, s[48:51], s60 offen offset:0 sc1
    buffer_store_dwordx4 v[36:39], v89, s[48:51], s60 offen offset:512 sc1
    buffer_store_dwordx4 v[40:43], v89, s[48:51], s60 offen offset:1024 sc1
    buffer_store_dwordx4 v[44:47], v89, s[48:51], s60 offen offset:1536 sc1
    s_mov_b64 exec, -1
    s_branch L_fin
L_kfac:
    v_lshrrev_b32 v6, 5, v0
    s_and_b32 s56, s3, 2
    v_add_u32 v6, s56, v6
    v_lshlrev_b32 v10, 6, v6
    s_mov_b32 s96, 400000
spin_21:
    ds_read_b128 v[16:19], v10 offset:22144
    ds_read_b128 v[20:23], v10 offset:22160
    ds_read_b128 v[24:27], v10 offset:22176
    ds_read_b128 v[28:31], v10 offset:22192
    s_waitcnt lgkmcnt(0)
    v_and_b32 v8, v18, v22
    v_and_b32 v9, v26, v30
    v_and_b32 v8, v8, v9
    v_cmp_ne_u32 vcc, 1, v8
    s_cbranch_vccz spind_22
    s_sleep 4
    s_sub_u32 s96, s96, 1
    s_cbranch_scc0 spin_21
spind_22:
    v_max3_f32 v32, v16, v20, v24
    v_max_f32 v32, v32, v28
    s_mov_b32 s69, 1069066811
    v_sub_f32 v60, v16, v32
    v_sub_f32 v61, v20, v32
    v_sub_f32 v62, v24, v32
    v_sub_f32 v63, v28, v32
    v_mul_f32 v60, s69, v60
    v_mul_f32 v61, s69, v61
    v_mul_f32 v62, s69, v62
    v_mul_f32 v63, s69, v63
    v_exp_f32 v60, v60
    v_exp_f32 v61, v61
    v_exp_f32 v62, v62
    v_exp_f32 v63, v63
    v_mul_f32 v33, v60, v17
    v_fmac_f32 v33, v61, v21
    v_fmac_f32 v33, v62, v25
    v_fmac_f32 v33, v63, v29
    v_mov_b32 v34, v32
    v_mov_b32 v35, v33
    v_bfi_b32 v32, v3, s41, v32
    v_bfi_b32 v33, v3, s42, v33
    v_bfi_b32 v34, v3, s43, v34
    v_bfi_b32 v35, v3, s44, v35
    s_lshr_b32 s56, s2, 5
    s_lshl_b32 s57, s56, 11
    s_bfe_u32 s58, s2, 196610
    s_lshl_b32 s60, s58, 6
    s_add_u32 s57, s57, s60
    s_lshl_b32 s61, s59, 4
    s_add_u32 s57, s57, s61
    s_add_u32 s57, s57, 1114112
    v_lshlrev_b32 v10, 9, v6
    s_mov_b32 s96, 400000
L_md:
    ds_read_b32 v8, v15 offset:22592
    s_waitcnt lgkmcnt(0)
    v_readfirstlane_b32 s70, v8
    s_cmp_lg_u32 s70, 0
    s_cbranch_scc1 L_mdd
    s_sleep 2
    s_sub_u32 s96, s96, 1
    s_cbranch_scc0 L_md
L_mdd:
    s_mov_b32 s62, 1
    s_mov_b32 s63, 1
    s_mov_b64 exec, s[62:63]
    s_cmp_eq_u32 s70, 2
    s_cbranch_scc1 L_mll
    buffer_store_dwordx4 v[32:35], v10, s[48:51], s57 offen sc1
    s_branch L_mld
L_mll:
    buffer_store_dwordx4 v[32:35], v10, s[48:51], s57 offen
L_mld:
    s_mov_b64 exec, -1
    v_and_b32 v8, 1, v0
    v_lshlrev_b32 v64, 10, v8
    v_lshl_add_u32 v64, v6, 8, v64
    v_and_b32 v9, 31, v0
    v_lshrrev_b32 v8, 1, v9
    v_lshl_add_u32 v64, v8, 4, v64
    v_lshlrev_b32 v65, 14, v6
    v_lshl_add_u32 v65, v9, 6, v65
    s_lshl_b32 s57, s56, 16
    s_lshl_b32 s58, s58, 11
    s_add_u32 s57, s57, s58
    s_add_u32 s57, s57, s61
    s_add_u32 s47, s57, 589824
    s_cmp_lg_u32 s3, 0
    s_cbranch_scc1 L_k3b
    s_lshr_b32 s57, s2, 3
    s_lshl_b32 s57, s57, 9
    s_add_u32 s63, s57, 1114112
    v_lshlrev_b32 v11, 4, v9
    v_lshlrev_b32 v10, 2, v9
    s_mov_b32 s96, 400000
cr_23:
    ds_read_b32 v8, v15 offset:22576
    s_waitcnt lgkmcnt(0)
    v_readfirstlane_b32 s97, v8
    s_cmp_ge_i32 s97, 30
    s_cbranch_scc1 crd_24
    s_sleep 4
    s_sub_u32 s96, s96, 1
    s_cbranch_scc0 cr_23
crd_24:
    s_mov_b32 s96, 40000
poll_25:
    buffer_load_dwordx4 v[20:23], v11, s[48:51], s63 offen sc1
    s_waitcnt vmcnt(0)
    v_msad_u8 v8, v20, s41, 0
    v_msad_u8 v8, v21, s42, v8
    v_msad_u8 v8, v22, s43, v8
    v_msad_u8 v8, v23, s44, v8
    v_cmp_ne_u32 vcc, 0, v8
    s_cbranch_vccz polld_26
    s_sleep 4
    s_sub_u32 s96, s96, 1
    s_cbranch_scc0 poll_25
polld_26:
    v_and_b32 v20, 0xffffff00, v20
    s_nop 1
    v_max_f32_dpp v24, v20, v20 quad_perm:[1,0,3,2] row_mask:0xf bank_mask:0xf
    s_nop 1
    v_max_f32_dpp v24, v24, v24 quad_perm:[2,3,0,1] row_mask:0xf bank_mask:0xf
    v_sub_f32 v24, v20, v24
    v_mul_f32 v24, s69, v24
    v_exp_f32 v24, v24
    s_nop 0
    v_mul_f32 v25, v24, v21
    s_nop 1
    v_add_f32_dpp v25, v25, v25 quad_perm:[1,0,3,2] row_mask:0xf bank_mask:0xf
    s_nop 1
    v_add_f32_dpp v25, v25, v25 quad_perm:[2,3,0,1] row_mask:0xf bank_mask:0xf
    v_rcp_f32 v25, v25
    s_nop 0
    v_mul_f32 v24, v24, v25
    ds_write_b32 v10, v24 offset:22656
    ds_write_b32 v15, v14 offset:22596
L_kpub:
    s_mov_b32 s96, 400000
spin_27:
    ds_read_b32 v8, v15 offset:22596
    s_waitcnt lgkmcnt(0)
    v_cmp_ne_u32 vcc, 1, v8
    s_cbranch_vccz spind_28
    s_sleep 4
    s_sub_u32 s96, s96, 1
    s_cbranch_scc0 spin_27
spind_28:
    ds_read_b32 v100, v85 offset:22656
    s_mov_b32 s64, 0x11111111
    s_mov_b32 s65, 0x11111111
    s_mov_b32 s66, 0x00ff00ff
    s_mov_b32 s67, 0x00ff00ff
    s_mov_b32 s96, 400000
cr_29:
    ds_read_b32 v8, v15 offset:22576
    s_waitcnt lgkmcnt(0)
    v_readfirstlane_b32 s97, v8
    s_cmp_ge_i32 s97, 36
    s_cbranch_scc1 crd_30
    s_sleep 4
    s_sub_u32 s96, s96, 1
    s_cbranch_scc0 cr_29
crd_30:
    s_mov_b32 s96, 400000
cr_31:
    ds_read_b32 v8, v15 offset:22576
    s_waitcnt lgkmcnt(0)
    v_readfirstlane_b32 s97, v8
    s_cmp_ge_i32 s97, 38
    s_cbranch_scc1 crd_32
    s_sub_u32 s96, s96, 1
    s_cbranch_scc0 cr_31
crd_32:
    ds_read_b128 v[16:19], v64 offset:10624
    ds_read_b128 v[20:23], v64 offset:12672
    ds_read_b128 v[24:27], v64 offset:14720
    ds_read_b128 v[28:31], v64 offset:16768
    s_waitcnt lgkmcnt(3)
    v_mul_f32 v16, v60, v16
    v_mul_f32 v17, v60, v17
    v_mul_f32 v18, v60, v18
    v_mul_f32 v19, v60, v19
    s_waitcnt lgkmcnt(2)
    v_fmac_f32 v16, v61, v20
    v_fmac_f32 v17, v61, v21
    v_fmac_f32 v18, v61, v22
    v_fmac_f32 v19, v61, v23
    s_waitcnt lgkmcnt(1)
    v_fmac_f32 v16, v62, v24
    v_fmac_f32 v17, v62, v25
    v_fmac_f32 v18, v62, v26
    v_fmac_f32 v19, v62, v27
    s_waitcnt lgkmcnt(0)
    v_fmac_f32 v16, v63, v28
    v_fmac_f32 v17, v63, v29
    v_fmac_f32 v18, v63, v30
    v_fmac_f32 v19, v63, v31
    v_bfi_b32 v16, v3, s41, v16
    v_bfi_b32 v17, v3, s42, v17
    v_bfi_b32 v18, v3, s43, v18
    v_bfi_b32 v19, v3, s44, v19
    s_cmp_eq_u32 s70, 2
    s_cbranch_scc0 L_kpg
    buffer_store_dwordx4 v[16:19], v65, s[48:51], s47 offen
    s_branch L_kpost
L_kpg:
    buffer_store_dwordx4 v[16:19], v65, s[48:51], s47 offen sc1
L_kpost:
    s_mov_b64 exec, 1
    ds_add_u32 v15, v14 offset:22576
    s_mov_b64 exec, -1
    s_cmp_eq_u32 s3, 0
    s_cbranch_scc1 L_k0c
    v_mov_b32 v8, 16
    s_waitcnt vmcnt(1)
    s_mov_b64 exec, 1
    ds_add_u32 v15, v8 offset:22608
    s_mov_b64 exec, -1
    s_branch L_fin
L_k0c:
    s_mov_b32 s96, 400000
cr_33:
    ds_read_b32 v8, v15 offset:22576
    s_waitcnt lgkmcnt(0)
    v_readfirstlane_b32 s97, v8
    s_cmp_ge_i32 s97, 40
    s_cbranch_scc1 crd_34
    s_sub_u32 s96, s96, 1
    s_cbranch_scc0 cr_33
crd_34:
    s_sleep 2
    ds_read_b32 v101, v85 offset:22704
    s_add_u32 s47, s46, 6144
    s_mov_b32 s96, 40000
poll_35:
    buffer_load_dwordx4 v[16:19], v84, s[48:51], s46 offen sc1
    buffer_load_dwordx4 v[20:23], v84, s[48:51], s46 offen offset:1024 sc1
    buffer_load_dwordx4 v[24:27], v84, s[48:51], s47 offen sc1
    buffer_load_dwordx4 v[28:31], v84, s[48:51], s47 offen offset:1024 sc1
    s_waitcnt vmcnt(3)
    v_msad_u8 v8, v16, s41, 0
    v_msad_u8 v8, v17, s42, v8
    v_msad_u8 v8, v18, s43, v8
    v_msad_u8 v8, v19, s44, v8
    s_waitcnt vmcnt(2)
    v_msad_u8 v8, v20, s41, v8
    v_msad_u8 v8, v21, s42, v8
    v_msad_u8 v8, v22, s43, v8
    v_msad_u8 v8, v23, s44, v8
    s_waitcnt vmcnt(1)
    v_msad_u8 v8, v24, s41, v8
    v_msad_u8 v8, v25, s42, v8
    v_msad_u8 v8, v26, s43, v8
    v_msad_u8 v8, v27, s44, v8
    s_waitcnt vmcnt(0)
    v_msad_u8 v8, v28, s41, v8
    v_msad_u8 v8, v29, s42, v8
    v_msad_u8 v8, v30, s43, v8
    v_msad_u8 v8, v31, s44, v8
    v_cmp_ne_u32 vcc, 0, v8
    s_cbranch_vccz polld_36
    s_sub_u32 s96, s96, 1
    s_cbranch_scc0 poll_35
polld_36:
    s_waitcnt lgkmcnt(0)
    v_mul_f32 v16, v100, v16
    v_mul_f32 v17, v100, v17
    v_mul_f32 v18, v100, v18
    v_mul_f32 v19, v100, v19
    v_mul_f32 v20, v100, v20
    v_mul_f32 v21, v100, v21
    v_mul_f32 v22, v100, v22
    v_mul_f32 v23, v100, v23
    v_mul_f32 v24, v101, v24
    v_mul_f32 v25, v101, v25
    v_mul_f32 v26, v101, v26
    v_mul_f32 v27, v101, v27
    v_mul_f32 v28, v101, v28
    v_mul_f32 v29, v101, v29
    v_mul_f32 v30, v101, v30
    v_mul_f32 v31, v101, v31
    v_add_f32_dpp v16, v16, v16 quad_perm:[1,0,3,2] row_mask:0xf bank_mask:0xf
    v_add_f32_dpp v17, v17, v17 quad_perm:[1,0,3,2] row_mask:0xf bank_mask:0xf
    v_add_f32_dpp v18, v18, v18 quad_perm:[1,0,3,2] row_mask:0xf bank_mask:0xf
    v_add_f32_dpp v19, v19, v19 quad_perm:[1,0,3,2] row_mask:0xf bank_mask:0xf
    v_add_f32_dpp v20, v20, v20 quad_perm:[1,0,3,2] row_mask:0xf bank_mask:0xf
    v_add_f32_dpp v21, v21, v21 quad_perm:[1,0,3,2] row_mask:0xf bank_mask:0xf
    v_add_f32_dpp v22, v22, v22 quad_perm:[1,0,3,2] row_mask:0xf bank_mask:0xf
    v_add_f32_dpp v23, v23, v23 quad_perm:[1,0,3,2] row_mask:0xf bank_mask:0xf
    v_add_f32_dpp v24, v24, v24 quad_perm:[1,0,3,2] row_mask:0xf bank_mask:0xf
    v_add_f32_dpp v25, v25, v25 quad_perm:[1,0,3,2] row_mask:0xf bank_mask:0xf
    v_add_f32_dpp v26, v26, v26 quad_perm:[1,0,3,2] row_mask:0xf bank_mask:0xf
    v_add_f32_dpp v27, v27, v27 quad_perm:[1,0,3,2] row_mask:0xf bank_mask:0xf
    v_add_f32_dpp v28, v28, v28 quad_perm:[1,0,3,2] row_mask:0xf bank_mask:0xf
    v_add_f32_dpp v29, v29, v29 quad_perm:[1,0,3,2] row_mask:0xf bank_mask:0xf
    v_add_f32_dpp v30, v30, v30 quad_perm:[1,0,3,2] row_mask:0xf bank_mask:0xf
    v_add_f32_dpp v31, v31, v31 quad_perm:[1,0,3,2] row_mask:0xf bank_mask:0xf
    v_add_f32_dpp v16, v16, v16 quad_perm:[2,3,0,1] row_mask:0xf bank_mask:0xf
    v_add_f32_dpp v17, v17, v17 quad_perm:[2,3,0,1] row_mask:0xf bank_mask:0xf
    v_add_f32_dpp v18, v18, v18 quad_perm:[2,3,0,1] row_mask:0xf bank_mask:0xf
    v_add_f32_dpp v19, v19, v19 quad_perm:[2,3,0,1] row_mask:0xf bank_mask:0xf
    v_add_f32_dpp v20, v20, v20 quad_perm:[2,3,0,1] row_mask:0xf bank_mask:0xf
    v_add_f32_dpp v21, v21, v21 quad_perm:[2,3,0,1] row_mask:0xf bank_mask:0xf
    v_add_f32_dpp v22, v22, v22 quad_perm:[2,3,0,1] row_mask:0xf bank_mask:0xf
    v_add_f32_dpp v23, v23, v23 quad_perm:[2,3,0,1] row_mask:0xf bank_mask:0xf
    v_add_f32_dpp v24, v24, v24 quad_perm:[2,3,0,1] row_mask:0xf bank_mask:0xf
    v_add_f32_dpp v25, v25, v25 quad_perm:[2,3,0,1] row_mask:0xf bank_mask:0xf
    v_add_f32_dpp v26, v26, v26 quad_perm:[2,3,0,1] row_mask:0xf bank_mask:0xf
    v_add_f32_dpp v27, v27, v27 quad_perm:[2,3,0,1] row_mask:0xf bank_mask:0xf
    v_add_f32_dpp v28, v28, v28 quad_perm:[2,3,0,1] row_mask:0xf bank_mask:0xf
    v_add_f32_dpp v29, v29, v29 quad_perm:[2,3,0,1] row_mask:0xf bank_mask:0xf
    v_add_f32_dpp v30, v30, v30 quad_perm:[2,3,0,1] row_mask:0xf bank_mask:0xf
    v_add_f32_dpp v31, v31, v31 quad_perm:[2,3,0,1] row_mask:0xf bank_mask:0xf
    v_cvt_pk_bf16_f32 v32, v16, v17
    v_cvt_pk_bf16_f32 v33, v18, v19
    v_cvt_pk_bf16_f32 v34, v20, v21
    v_cvt_pk_bf16_f32 v35, v22, v23
    v_cvt_pk_bf16_f32 v36, v24, v25
    v_cvt_pk_bf16_f32 v37, v26, v27
    v_cvt_pk_bf16_f32 v38, v28, v29
    v_cvt_pk_bf16_f32 v39, v30, v31
    s_mov_b64 exec, s[64:65]
    ds_write_b64 v86, v[32:33] offset:18816
    ds_write_b64 v86, v[34:35] offset:18944
    ds_write_b64 v86, v[36:37] offset:19632
    ds_write_b64 v86, v[38:39] offset:19760
    s_mov_b64 exec, 1
    ds_add_u32 v15, v14 offset:22608
    s_mov_b64 exec, -1
    s_branch L_fin
L_k2b:
    s_lshr_b32 s70, s2, 5
    s_lshl_b32 s70, s70, 16
    s_and_b32 s71, s2, 31
    s_lshl_b32 s71, s71, 6
    s_add_u32 s70, s70, s71
    s_and_b32 s61, s2, 7
    s_lshl_b32 s61, s61, 10
    s_lshr_b32 s71, s2, 3
    s_lshl_b32 s71, s71, 5
    s_add_u32 s61, s61, s71
    s_add_u32 s98, s70, 1179648
    s_add_u32 s99, s98, 0x8000
    s_add_u32 s52, s70, 1703936
    s_add_u32 s53, s52, 0x8000
    v_lshlrev_b32 v91, 3, v90
    v_lshl_add_u32 v91, v1, 1, v91
    buffer_load_ushort v80, v91, s[12:15], s61 offen
    v_lshrrev_b32 v13, 2, v0
    v_lshlrev_b32 v13, 11, v13
    v_lshl_add_u32 v13, v90, 4, v13
    s_mov_b32 s4, s34
    s_and_b32 s5, s35, 0xffff
    s_mov_b32 s6, 8192
    s_mov_b32 s7, 0x20000
    s_mov_b32 s10, 0x000f000f
    s_mov_b32 s11, 0x000f000f
    s_mov_b32 s62, 0
    s_mov_b32 s96, 400000
spin_37:
    ds_read_b32 v8, v15 offset:22596
    s_waitcnt lgkmcnt(0)
    v_cmp_ne_u32 vcc, 1, v8
    s_cbranch_vccz spind_38
    s_sleep 4
    s_sub_u32 s96, s96, 1
    s_cbranch_scc0 spin_37
spind_38:
    ds_read_b32 v100, v85 offset:22656
    s_mov_b32 s64, 0x11111111
    s_mov_b32 s65, 0x11111111
    s_mov_b32 s66, 0x00ff00ff
    s_mov_b32 s67, 0x00ff00ff
    s_mov_b32 s96, 400000
cr_39:
    ds_read_b32 v8, v15 offset:22576
    s_waitcnt lgkmcnt(0)
    v_readfirstlane_b32 s97, v8
    s_cmp_ge_i32 s97, 37
    s_cbranch_scc1 crd_40
    s_sleep 4
    s_sub_u32 s96, s96, 1
    s_cbranch_scc0 cr_39
crd_40:
    s_mov_b32 s96, 400000
cr_41:
    ds_read_b32 v8, v15 offset:22576
    s_waitcnt lgkmcnt(0)
    v_readfirstlane_b32 s97, v8
    s_cmp_ge_i32 s97, 40
    s_cbranch_scc1 crd_42
    s_sleep 1
    s_sub_u32 s96, s96, 1
    s_cbranch_scc0 cr_41
crd_42:
    s_sleep 2
    ds_read_b32 v101, v85 offset:22640
    s_add_u32 s47, s46, 4294965248
    s_mov_b32 s96, 40000
poll_43:
    buffer_load_dwordx4 v[16:19], v84, s[48:51], s46 offen sc1
    buffer_load_dwordx4 v[20:23], v84, s[48:51], s46 offen offset:1024 sc1
    buffer_load_dwordx4 v[24:27], v84, s[48:51], s47 offen sc1
    buffer_load_dwordx4 v[28:31], v84, s[48:51], s47 offen offset:1024 sc1
    s_waitcnt vmcnt(3)
    v_msad_u8 v8, v16, s41, 0
    v_msad_u8 v8, v17, s42, v8
    v_msad_u8 v8, v18, s43, v8
    v_msad_u8 v8, v19, s44, v8
    s_waitcnt vmcnt(2)
    v_msad_u8 v8, v20, s41, v8
    v_msad_u8 v8, v21, s42, v8
    v_msad_u8 v8, v22, s43, v8
    v_msad_u8 v8, v23, s44, v8
    s_waitcnt vmcnt(1)
    v_msad_u8 v8, v24, s41, v8
    v_msad_u8 v8, v25, s42, v8
    v_msad_u8 v8, v26, s43, v8
    v_msad_u8 v8, v27, s44, v8
    s_waitcnt vmcnt(0)
    v_msad_u8 v8, v28, s41, v8
    v_msad_u8 v8, v29, s42, v8
    v_msad_u8 v8, v30, s43, v8
    v_msad_u8 v8, v31, s44, v8
    v_cmp_ne_u32 vcc, 0, v8
    s_cbranch_vccz polld_44
    s_sub_u32 s96, s96, 1
    s_cbranch_scc0 poll_43
polld_44:
    s_waitcnt lgkmcnt(0)
    v_mul_f32 v16, v100, v16
    v_mul_f32 v17, v100, v17
    v_mul_f32 v18, v100, v18
    v_mul_f32 v19, v100, v19
    v_mul_f32 v20, v100, v20
    v_mul_f32 v21, v100, v21
    v_mul_f32 v22, v100, v22
    v_mul_f32 v23, v100, v23
    v_mul_f32 v24, v101, v24
    v_mul_f32 v25, v101, v25
    v_mul_f32 v26, v101, v26
    v_mul_f32 v27, v101, v27
    v_mul_f32 v28, v101, v28
    v_mul_f32 v29, v101, v29
    v_mul_f32 v30, v101, v30
    v_mul_f32 v31, v101, v31
    v_add_f32_dpp v16, v16, v16 quad_perm:[1,0,3,2] row_mask:0xf bank_mask:0xf
    v_add_f32_dpp v17, v17, v17 quad_perm:[1,0,3,2] row_mask:0xf bank_mask:0xf
    v_add_f32_dpp v18, v18, v18 quad_perm:[1,0,3,2] row_mask:0xf bank_mask:0xf
    v_add_f32_dpp v19, v19, v19 quad_perm:[1,0,3,2] row_mask:0xf bank_mask:0xf
    v_add_f32_dpp v20, v20, v20 quad_perm:[1,0,3,2] row_mask:0xf bank_mask:0xf
    v_add_f32_dpp v21, v21, v21 quad_perm:[1,0,3,2] row_mask:0xf bank_mask:0xf
    v_add_f32_dpp v22, v22, v22 quad_perm:[1,0,3,2] row_mask:0xf bank_mask:0xf
    v_add_f32_dpp v23, v23, v23 quad_perm:[1,0,3,2] row_mask:0xf bank_mask:0xf
    v_add_f32_dpp v24, v24, v24 quad_perm:[1,0,3,2] row_mask:0xf bank_mask:0xf
    v_add_f32_dpp v25, v25, v25 quad_perm:[1,0,3,2] row_mask:0xf bank_mask:0xf
    v_add_f32_dpp v26, v26, v26 quad_perm:[1,0,3,2] row_mask:0xf bank_mask:0xf
    v_add_f32_dpp v27, v27, v27 quad_perm:[1,0,3,2] row_mask:0xf bank_mask:0xf
    v_add_f32_dpp v28, v28, v28 quad_perm:[1,0,3,2] row_mask:0xf bank_mask:0xf
    v_add_f32_dpp v29, v29, v29 quad_perm:[1,0,3,2] row_mask:0xf bank_mask:0xf
    v_add_f32_dpp v30, v30, v30 quad_perm:[1,0,3,2] row_mask:0xf bank_mask:0xf
    v_add_f32_dpp v31, v31, v31 quad_perm:[1,0,3,2] row_mask:0xf bank_mask:0xf
    v_add_f32_dpp v16, v16, v16 quad_perm:[2,3,0,1] row_mask:0xf bank_mask:0xf
    v_add_f32_dpp v17, v17, v17 quad_perm:[2,3,0,1] row_mask:0xf bank_mask:0xf
    v_add_f32_dpp v18, v18, v18 quad_perm:[2,3,0,1] row_mask:0xf bank_mask:0xf
    v_add_f32_dpp v19, v19, v19 quad_perm:[2,3,0,1] row_mask:0xf bank_mask:0xf
    v_add_f32_dpp v20, v20, v20 quad_perm:[2,3,0,1] row_mask:0xf bank_mask:0xf
    v_add_f32_dpp v21, v21, v21 quad_perm:[2,3,0,1] row_mask:0xf bank_mask:0xf
    v_add_f32_dpp v22, v22, v22 quad_perm:[2,3,0,1] row_mask:0xf bank_mask:0xf
    v_add_f32_dpp v23, v23, v23 quad_perm:[2,3,0,1] row_mask:0xf bank_mask:0xf
    v_add_f32_dpp v24, v24, v24 quad_perm:[2,3,0,1] row_mask:0xf bank_mask:0xf
    v_add_f32_dpp v25, v25, v25 quad_perm:[2,3,0,1] row_mask:0xf bank_mask:0xf
    v_add_f32_dpp v26, v26, v26 quad_perm:[2,3,0,1] row_mask:0xf bank_mask:0xf
    v_add_f32_dpp v27, v27, v27 quad_perm:[2,3,0,1] row_mask:0xf bank_mask:0xf
    v_add_f32_dpp v28, v28, v28 quad_perm:[2,3,0,1] row_mask:0xf bank_mask:0xf
    v_add_f32_dpp v29, v29, v29 quad_perm:[2,3,0,1] row_mask:0xf bank_mask:0xf
    v_add_f32_dpp v30, v30, v30 quad_perm:[2,3,0,1] row_mask:0xf bank_mask:0xf
    v_add_f32_dpp v31, v31, v31 quad_perm:[2,3,0,1] row_mask:0xf bank_mask:0xf
    v_cvt_pk_bf16_f32 v32, v16, v17
    v_cvt_pk_bf16_f32 v33, v18, v19
    v_cvt_pk_bf16_f32 v34, v20, v21
    v_cvt_pk_bf16_f32 v35, v22, v23
    v_cvt_pk_bf16_f32 v36, v24, v25
    v_cvt_pk_bf16_f32 v37, v26, v27
    v_cvt_pk_bf16_f32 v38, v28, v29
    v_cvt_pk_bf16_f32 v39, v30, v31
    s_mov_b64 exec, s[64:65]
    ds_write_b64 v86, v[32:33] offset:18816
    ds_write_b64 v86, v[34:35] offset:18944
    ds_write_b64 v86, v[36:37] offset:18544
    ds_write_b64 v86, v[38:39] offset:18672
    s_mov_b64 exec, 1
    ds_add_u32 v15, v14 offset:22608
    s_mov_b64 exec, -1
    s_sleep 24
    s_cmp_eq_u32 s62, 1
    s_cbranch_scc1 L_gok
    buffer_load_dwordx4 v[64:67], v13, s[48:51], s52 offen sc1
    buffer_load_dwordx4 v[68:71], v13, s[48:51], s53 offen sc1
    buffer_load_dwordx4 v[16:19], v13, s[48:51], s98 offen sc1
    buffer_load_dwordx4 v[20:23], v13, s[48:51], s99 offen sc1
    s_waitcnt vmcnt(3)
    v_msad_u8 v8, v64, s41, 0
    v_msad_u8 v8, v65, s42, v8
    v_msad_u8 v8, v66, s43, v8
    v_msad_u8 v8, v67, s44, v8
    s_waitcnt vmcnt(2)
    v_msad_u8 v8, v68, s41, v8
    v_msad_u8 v8, v69, s42, v8
    v_msad_u8 v8, v70, s43, v8
    v_msad_u8 v8, v71, s44, v8
    v_cmp_ne_u32 vcc, 0, v8
    s_cbranch_vccz L_bok
    s_mov_b32 s96, 40000
poll_45:
    buffer_load_dwordx4 v[64:67], v13, s[48:51], s52 offen sc1
    buffer_load_dwordx4 v[68:71], v13, s[48:51], s53 offen sc1
    s_waitcnt vmcnt(1)
    v_msad_u8 v8, v64, s41, 0
    v_msad_u8 v8, v65, s42, v8
    v_msad_u8 v8, v66, s43, v8
    v_msad_u8 v8, v67, s44, v8
    s_waitcnt vmcnt(0)
    v_msad_u8 v8, v68, s41, v8
    v_msad_u8 v8, v69, s42, v8
    v_msad_u8 v8, v70, s43, v8
    v_msad_u8 v8, v71, s44, v8
    v_cmp_ne_u32 vcc, 0, v8
    s_cbranch_vccz polld_46
    s_sub_u32 s96, s96, 1
    s_cbranch_scc0 poll_45
polld_46:
L_bok:
    v_add_f32 v64, v64, v68
    v_add_f32 v65, v65, v69
    v_add_f32 v66, v66, v70
    v_add_f32 v67, v67, v71
    s_nop 0
    v_permlane32_swap_b32 v64, v66
    v_permlane32_swap_b32 v65, v67
    v_add_f32 v64, v64, v66
    v_add_f32 v65, v65, v67
    s_nop 1
    v_permlane16_swap_b32 v64, v65
    v_add_f32 v64, v64, v65
    s_nop 1
    v_add_f32_dpp v64, v64, v64 row_ror:8 row_mask:0xf bank_mask:0xf
    s_nop 1
    v_add_f32_dpp v64, v64, v64 row_ror:4 row_mask:0xf bank_mask:0xf
    v_cvt_pk_bf16_f32 v64, v64, v64
    v_lshlrev_b32 v64, 16, v64
    v_mul_f32 v65, 3216550459, v64
    v_exp_f32 v65, v65
    s_nop 0
    v_add_f32 v65, 1.0, v65
    v_rcp_f32 v65, v65
    s_nop 0
    v_mul_f32 v64, v64, v65
    v_cvt_pk_bf16_f32 v64, v64, v64
    v_lshlrev_b32 v64, 16, v64
    v_lshlrev_b32 v81, 16, v80
    s_waitcnt vmcnt(1)
    v_msad_u8 v8, v16, s41, 0
    v_msad_u8 v8, v17, s42, v8
    v_msad_u8 v8, v18, s43, v8
    v_msad_u8 v8, v19, s44, v8
    s_waitcnt vmcnt(0)
    v_msad_u8 v8, v20, s41, v8
    v_msad_u8 v8, v21, s42, v8
    v_msad_u8 v8, v22, s43, v8
    v_msad_u8 v8, v23, s44, v8
    v_cmp_ne_u32 vcc, 0, v8
    s_cbranch_vccz L_sok
L_gok:
    s_mov_b32 s96, 40000
poll_47:
    buffer_load_dwordx4 v[16:19], v13, s[48:51], s98 offen sc1
    buffer_load_dwordx4 v[20:23], v13, s[48:51], s99 offen sc1
    s_waitcnt vmcnt(1)
    v_msad_u8 v8, v16, s41, 0
    v_msad_u8 v8, v17, s42, v8
    v_msad_u8 v8, v18, s43, v8
    v_msad_u8 v8, v19, s44, v8
    s_waitcnt vmcnt(0)
    v_msad_u8 v8, v20, s41, v8
    v_msad_u8 v8, v21, s42, v8
    v_msad_u8 v8, v22, s43, v8
    v_msad_u8 v8, v23, s44, v8
    v_cmp_ne_u32 vcc, 0, v8
    s_cbranch_vccz polld_48
    s_sub_u32 s96, s96, 1
    s_cbranch_scc0 poll_47
polld_48:
L_sok:
    v_add_f32 v16, v16, v20
    v_add_f32 v17, v17, v21
    v_add_f32 v18, v18, v22
    v_add_f32 v19, v19, v23
    s_nop 0
    v_permlane32_swap_b32 v16, v18
    v_permlane32_swap_b32 v17, v19
    v_add_f32 v16, v16, v18
    v_add_f32 v17, v17, v19
    s_nop 1
    v_permlane16_swap_b32 v16, v17
    v_add_f32 v16, v16, v17
    s_nop 1
    v_add_f32_dpp v16, v16, v16 row_ror:8 row_mask:0xf bank_mask:0xf
    s_nop 1
    v_add_f32_dpp v16, v16, v16 row_ror:4 row_mask:0xf bank_mask:0xf
    v_cvt_pk_bf16_f32 v16, v16, v16
    v_lshlrev_b32 v16, 16, v16
    v_mul_f32 v16, v16, v64
    v_cvt_pk_bf16_f32 v16, v16, v16
    v_lshlrev_b32 v16, 16, v16
    v_add_f32 v16, v16, v81
    v_cvt_pk_bf16_f32 v16, v16, v16
    s_mov_b64 exec, s[10:11]
    buffer_store_short v16, v91, s[4:7], s61 offen
    s_cmp_lg_u32 s2, 0
    s_cbranch_scc1 L_fin
    v_mov_b32 v8, s45
    s_mov_b64 exec, 1
    buffer_store_dword v8, v15, s[48:51], 0 offen sc1
    s_branch L_fin
L_k3b:
    s_lshr_b32 s56, s2, 3
    s_lshl_b32 s56, s56, 17
    s_and_b32 s57, s2, 7
    s_lshl_b32 s57, s57, 7
    s_add_u32 s56, s56, s57
    s_add_u32 s8, s24, s56
    s_addc_u32 s9, s25, 0
    s_and_b32 s9, s9, 0xffff
    s_sub_u32 s10, 4194304, s56
    s_mov_b32 s11, 0x20000
    s_movk_i32 s60, 1024
    v_lshrrev_b32 v6, 3, v0
    v_and_b32 v10, 7, v0
    v_and_b32 v11, 2, v6
    v_xor_b32 v10, v10, v11
    v_xor_b32 v11, 4, v10
    v_mul_lo_u32 v6, v6, s60
    v_lshl_add_u32 v10, v10, 4, v6
    v_lshl_add_u32 v11, v11, 4, v6
    s_mov_b32 s96, 400000
cr_49:
    ds_read_b32 v8, v15 offset:22576
    s_waitcnt lgkmcnt(0)
    v_readfirstlane_b32 s97, v8
    s_cmp_ge_i32 s97, 33
    s_cbranch_scc1 crd_50
    s_sleep 4
    s_sub_u32 s96, s96, 1
    s_cbranch_scc0 cr_49
crd_50:
    s_mov_b32 s96, 400000
cr_51:
    ds_read_b32 v8, v15 offset:22576
    s_waitcnt lgkmcnt(0)
    v_readfirstlane_b32 s97, v8
    s_cmp_ge_i32 s97, 36
    s_cbranch_scc1 crd_52
    s_sleep 1
    s_sub_u32 s96, s96, 1
    s_cbranch_scc0 cr_51
crd_52:
    s_mov_b32 m0, 32768
    s_mov_b32 s60, 0
    s_mov_b32 s61, 7168
    s_mov_b32 s62, 14336
    s_mov_b32 s63, 21504
    buffer_load_dwordx4 v10, s[8:11], s60 offen offset:0 nt lds
    buffer_load_dwordx4 v11, s[8:11], s61 offen offset:1024 nt lds
    buffer_load_dwordx4 v10, s[8:11], s62 offen offset:2048 nt lds
    buffer_load_dwordx4 v11, s[8:11], s63 offen offset:3072 nt lds
    s_mov_b32 m0, 36864
    s_mov_b32 s60, 32768
    s_mov_b32 s61, 39936
    s_mov_b32 s62, 47104
    s_mov_b32 s63, 54272
    buffer_load_dwordx4 v10, s[8:11], s60 offen offset:0 nt lds
    buffer_load_dwordx4 v11, s[8:11], s61 offen offset:1024 nt lds
    buffer_load_dwordx4 v10, s[8:11], s62 offen offset:2048 nt lds
    buffer_load_dwordx4 v11, s[8:11], s63 offen offset:3072 nt lds
    s_mov_b32 s96, 400000
cr_53:
    ds_read_b32 v8, v15 offset:22576
    s_waitcnt lgkmcnt(0)
    v_readfirstlane_b32 s97, v8
    s_cmp_ge_i32 s97, 37
    s_cbranch_scc1 crd_54
    s_sleep 1
    s_sub_u32 s96, s96, 1
    s_cbranch_scc0 cr_53
crd_54:
    s_mov_b32 m0, 40960
    s_mov_b32 s60, 65536
    s_mov_b32 s61, 72704
    s_mov_b32 s62, 79872
    s_mov_b32 s63, 87040
    buffer_load_dwordx4 v10, s[8:11], s60 offen offset:0 nt lds
    buffer_load_dwordx4 v11, s[8:11], s61 offen offset:1024 nt lds
    buffer_load_dwordx4 v10, s[8:11], s62 offen offset:2048 nt lds
    buffer_load_dwordx4 v11, s[8:11], s63 offen offset:3072 nt lds
    s_mov_b32 m0, 45056
    s_mov_b32 s60, 98304
    s_mov_b32 s61, 105472
    s_mov_b32 s62, 112640
    s_mov_b32 s63, 119808
    buffer_load_dwordx4 v10, s[8:11], s60 offen offset:0 nt lds
    buffer_load_dwordx4 v11, s[8:11], s61 offen offset:1024 nt lds
    buffer_load_dwordx4 v10, s[8:11], s62 offen offset:2048 nt lds
    buffer_load_dwordx4 v11, s[8:11], s63 offen offset:3072 nt lds
    s_branch L_kpub
L_vwave:
    s_add_u32 s4, s20, s56
    s_addc_u32 s5, s21, 0
    s_and_b32 s5, s5, 0xffff
    s_mov_b32 s71, s58
    v_mov_b32 v3, 0xff
    v_mov_b32 v13, 0
    v_mov_b32 v91, 0
    s_lshl_b32 s68, s3, 2
    s_add_i32 s68, s68, 3
    s_barrier
    s_mov_b64 exec, 1
    ds_add_u32 v15, v14 offset:22576
    s_mov_b64 exec, -1
    s_waitcnt lgkmcnt(0)
    s_add_u32 s45, s40, 1
    s_mul_i32 s40, s45, 0x9E3779B1
    s_bfe_u32 s41, s40, 458752
    s_lshl_b32 s41, s41, 1
    s_or_b32 s41, s41, 1
    s_bfe_u32 s42, s40, 458759
    s_lshl_b32 s42, s42, 1
    s_or_b32 s42, s42, 1
    s_bfe_u32 s43, s40, 458766
    s_lshl_b32 s43, s43, 1
    s_or_b32 s43, s43, 1
    s_bfe_u32 s44, s40, 458773
    s_lshl_b32 s44, s44, 1
    s_or_b32 s44, s44, 1
    s_mov_b32 s48, s38
    s_and_b32 s49, s39, 0xffff
    s_mov_b32 s50, 2228224
    s_mov_b32 s51, 0x20000
    s_lshr_b32 s56, s2, 3
    s_lshl_b32 s57, s56, 14
    s_lshl_b32 s58, s3, 11
    s_add_u32 s46, s57, s58
    s_add_u32 s46, s46, 589824
    v_and_b32 v90, 3, v0
    v_lshrrev_b32 v8, 2, v0
    v_lshlrev_b32 v84, 4, v0
    s_lshl_b32 s58, s3, 4
    v_lshl_add_u32 v85, v90, 2, s58
    s_mul_i32 s57, s3, 272
    v_lshl_add_u32 v86, v8, 3, s57
    v_and_b32 v87, 7, v2
    v_mul_u32_u24 v87, 272, v87
    v_lshl_add_u32 v87, v1, 4, v87
    s_and_b32 s57, s2, 7
    s_lshl_b32 s57, s57, 16
    s_lshl_b32 s58, s56, 11
    s_add_u32 s57, s57, s58
    s_and_b32 s58, s3, 3
    s_lshl_b32 s58, s58, 9
    s_add_u32 s57, s57, s58
    s_add_u32 s1, s57, 1179648
    v_lshlrev_b32 v89, 6, v2
    v_lshl_add_u32 v89, v1, 4, v89
    v_lshrrev_b32 v8, 2, v2
    v_lshl_add_u32 v88, v1, 3, v8
    v_lshlrev_b32 v88, 7, v88
    v_lshrrev_b32 v8, 1, v8
    v_and_b32 v9, 1, v1
    v_lshl_or_b32 v8, v9, 1, v8
    v_lshl_add_u32 v88, v8, 5, v88
    v_lshl_add_u32 v88, v90, 3, v88
    s_cmp_ge_u32 s67, 240
    s_cbranch_scc1 L_vnos1
    v_lshlrev_b32 v10, 4, v6
    v_mul_u32_u24 v11, 528, v6
    v_lshl_add_u32 v11, v7, 4, v11
    s_lshl_b32 s66, s71, 7
    v_add_u32 v11, s66, v11
    v_and_b32 v12, 7, v2
    v_mul_u32_u24 v12, 528, v12
    v_lshl_add_u32 v12, v1, 4, v12
    s_lshl_b32 s66, s71, 5
    v_xor_b32 v47, s66, v88
    v_add_u32 v47, 49152, v47
    s_lshr_b32 s66, s67, 1
    s_lshl_b32 s66, s66, 11
    s_mul_i32 s69, s62, 245760
    s_add_u32 s66, s66, s69
    s_lshl_b32 s69, s71, 9
    s_add_u32 s66, s66, s69
    s_add_u32 s69, s66, 65536
    s_lshl_b32 s70, s71, 2
    s_add_u32 s70, s70, 22528
    v_lshlrev_b32 v44, 2, v90
    s_mov_b32 s66, 0x00ff00ff
    s_mov_b32 s67, 0x00ff00ff
    s_waitcnt vmcnt(0)
    s_cmp_lt_u32 s71, 2
    s_cbranch_scc1 L_vnp
    s_mov_b64 exec, 1
    ds_add_u32 v15, v14 offset:22576
    s_mov_b64 exec, -1
L_vnp:
    s_mov_b32 s96, 400000
spin_55:
    ds_read_b128 v[16:19], v10 offset:22400
    s_waitcnt lgkmcnt(0)
    v_cmp_ne_u32 vcc, 1, v18
    s_cbranch_vccz spind_56
    s_sleep 1
    s_sub_u32 s96, s96, 1
    s_cbranch_scc0 spin_55
spind_56:
    v_lshlrev_b32 v24, 16, v48
    v_and_b32 v25, 0xffff0000, v48
    v_lshlrev_b32 v26, 16, v49
    v_and_b32 v27, 0xffff0000, v49
    v_lshlrev_b32 v28, 16, v50
    v_and_b32 v29, 0xffff0000, v50
    v_lshlrev_b32 v30, 16, v51
    v_and_b32 v31, 0xffff0000, v51
    v_sub_f32 v24, v24, v16
    v_sub_f32 v25, v25, v16
    v_sub_f32 v26, v26, v16
    v_sub_f32 v27, v27, v16
    v_sub_f32 v28, v28, v16
    v_sub_f32 v29, v29, v16
    v_sub_f32 v30, v30, v16
    v_sub_f32 v31, v31, v16
    v_cvt_pk_bf16_f32 v48, v24, v25
    v_cvt_pk_bf16_f32 v49, v26, v27
    v_cvt_pk_bf16_f32 v50, v28, v29
    v_cvt_pk_bf16_f32 v51, v30, v31
    v_lshlrev_b32 v24, 16, v48
    v_and_b32 v25, 0xffff0000, v48
    v_lshlrev_b32 v26, 16, v49
    v_and_b32 v27, 0xffff0000, v49
    v_lshlrev_b32 v28, 16, v50
    v_and_b32 v29, 0xffff0000, v50
    v_lshlrev_b32 v30, 16, v51
    v_and_b32 v31, 0xffff0000, v51
    v_mul_f32 v24, v24, v17
    v_mul_f32 v25, v25, v17
    v_mul_f32 v26, v26, v17
    v_mul_f32 v27, v27, v17
    v_mul_f32 v28, v28, v17
    v_mul_f32 v29, v29, v17
    v_mul_f32 v30, v30, v17
    v_mul_f32 v31, v31, v17
    v_cvt_pk_bf16_f32 v48, v24, v25
    v_cvt_pk_bf16_f32 v49, v26, v27
    v_cvt_pk_bf16_f32 v50, v28, v29
    v_cvt_pk_bf16_f32 v51, v30, v31
    ds_write_b128 v11, v[48:51] offset:0
    v_mov_b32 v9, s70
    s_mov_b64 exec, 1
    ds_write_b32 v9, v14
    s_mov_b64 exec, -1
    s_mov_b32 s96, 400000
spin_57:
    ds_read_b32 v8, v44 offset:22528
    s_waitcnt lgkmcnt(0)
    v_cmp_ne_u32 vcc, 1, v8
    s_cbranch_vccz spind_58
    s_sleep 1
    s_sub_u32 s96, s96, 1
    s_cbranch_scc0 spin_57
spind_58:
    ds_read_b128 v[128:131], v12 offset:0
    ds_read_b64_tr_b16 v[160:161], v47 offset:0
    ds_read_b64_tr_b16 v[162:163], v47 offset:512
    ds_read_b128 v[132:135], v12 offset:64
    ds_read_b64_tr_b16 v[164:165], v47 offset:4096
    ds_read_b64_tr_b16 v[166:167], v47 offset:4608
    ds_read_b128 v[136:139], v12 offset:128
    ds_read_b64_tr_b16 v[168:169], v47 offset:8192
    ds_read_b64_tr_b16 v[170:171], v47 offset:8704
    ds_read_b128 v[140:143], v12 offset:192
    ds_read_b64_tr_b16 v[172:173], v47 offset:12288
    ds_read_b64_tr_b16 v[174:175], v47 offset:12800
    ds_read_b128 v[144:147], v12 offset:256
    ds_read_b64_tr_b16 v[176:177], v47 offset:16384
    ds_read_b64_tr_b16 v[178:179], v47 offset:16896
    s_waitcnt lgkmcnt(12)
    v_mfma_f32_16x16x32_bf16 v[16:19], v[160:163], v[128:131], 0
    ds_read_b128 v[148:151], v12 offset:320
    ds_read_b64_tr_b16 v[180:181], v47 offset:20480
    ds_read_b64_tr_b16 v[182:183], v47 offset:20992
    s_waitcnt lgkmcnt(12)
    v_mfma_f32_16x16x32_bf16 v[16:19], v[164:167], v[132:135], v[16:19]
    ds_read_b128 v[152:155], v12 offset:384
    ds_read_b64_tr_b16 v[184:185], v47 offset:24576
    ds_read_b64_tr_b16 v[186:187], v47 offset:25088
    s_waitcnt lgkmcnt(12)
    v_mfma_f32_16x16x32_bf16 v[16:19], v[168:171], v[136:139], v[16:19]
    ds_read_b128 v[156:159], v12 offset:448
    ds_read_b64_tr_b16 v[188:189], v47 offset:28672
    ds_read_b64_tr_b16 v[190:191], v47 offset:29184
    s_waitcnt lgkmcnt(12)
    v_mfma_f32_16x16x32_bf16 v[16:19], v[172:175], v[140:143], v[16:19]
    s_waitcnt lgkmcnt(9)
    v_mfma_f32_16x16x32_bf16 v[16:19], v[176:179], v[144:147], v[16:19]
    s_waitcnt lgkmcnt(6)
    v_mfma_f32_16x16x32_bf16 v[16:19], v[180:183], v[148:151], v[16:19]
    s_waitcnt lgkmcnt(3)
    v_mfma_f32_16x16x32_bf16 v[16:19], v[184:187], v[152:155], v[16:19]
    s_waitcnt lgkmcnt(0)
    v_mfma_f32_16x16x32_bf16 v[16:19], v[188:191], v[156:159], v[16:19]
    s_nop 7
    v_bfi_b32 v16, v3, s41, v16
    v_bfi_b32 v17, v3, s42, v17
    v_bfi_b32 v18, v3, s43, v18
    v_bfi_b32 v19, v3, s44, v19
    s_mov_b64 exec, s[66:67]
    buffer_store_dwordx4 v[16:19], v89, s[48:51], s69 offen sc1
    s_mov_b64 exec, -1
    s_branch L_vload
L_vnos1:
    s_cmp_lt_u32 s71, 2
    s_cbranch_scc1 L_vnp2
    s_mov_b64 exec, 1
    ds_add_u32 v15, v14 offset:22576
    s_mov_b64 exec, -1
L_vnp2:
L_vload:
    v_lshlrev_b32 v4, 4, v0
    s_mov_b32 s60, 0
    s_mov_b32 s61, 4096
    s_mov_b32 s62, 8192
    s_mov_b32 s63, 12288
    s_mov_b32 s64, 16384
    s_mov_b32 s65, 20480
    s_mov_b32 s66, 24576
    s_mov_b32 s67, 28672
    v_and_b32 v7, 3, v0
    v_lshrrev_b32 v6, 2, v2
    v_mov_b32 v10, 0x0c0c0c0c
    v_mov_b32 v11, 202113280
    v_mov_b32 v12, 16780300
    v_cmp_eq_u32 vcc, 0, v7
    s_nop 1
    v_cndmask_b32 v32, v10, v11, vcc
    v_cmp_eq_u32 vcc, 1, v7
    s_nop 1
    v_cndmask_b32 v32, v32, v12, vcc
    v_cmp_eq_u32 vcc, 2, v7
    s_nop 1
    v_cndmask_b32 v33, v10, v11, vcc
    v_cmp_eq_u32 vcc, 3, v7
    s_nop 1
    v_cndmask_b32 v33, v33, v12, vcc
    v_mov_b32 v11, 202113794
    v_mov_b32 v12, 50465804
    v_cmp_eq_u32 vcc, 0, v7
    s_nop 1
    v_cndmask_b32 v34, v10, v11, vcc
    v_cmp_eq_u32 vcc, 1, v7
    s_nop 1
    v_cndmask_b32 v34, v34, v12, vcc
    v_cmp_eq_u32 vcc, 2, v7
    s_nop 1
    v_cndmask_b32 v35, v10, v11, vcc
    v_cmp_eq_u32 vcc, 3, v7
    s_nop 1
    v_cndmask_b32 v35, v35, v12, vcc
    v_mov_b32 v40, 0
    v_mov_b32 v41, 0
    v_mov_b32 v44, 0
    v_mov_b32 v45, 0
    v_mov_b32 v48, 0
    v_mov_b32 v49, 0
    v_mov_b32 v52, 0
    v_mov_b32 v53, 0
    v_mov_b32 v56, 0
    v_mov_b32 v57, 0
    v_mov_b32 v60, 0
    v_mov_b32 v61, 0
    v_mov_b32 v64, 0
    v_mov_b32 v65, 0
    v_mov_b32 v68, 0
    v_mov_b32 v69, 0
    v_mov_b32 v72, 0
    v_mov_b32 v73, 0
    v_lshl_add_u32 v10, v6, 2, v1
    v_mul_u32_u24 v10, 80, v10
    s_mul_i32 s56, s71, 1280
    v_add_u32 v10, s56, v10
    s_lshl_b32 s56, s71, 2
    v_mov_b32 v11, s56
    s_lshl_b32 s56, s71, 11
    v_lshlrev_b32 v12, 4, v0
    v_add_u32 v12, s56, v12
    s_sub_i32 s70, s68, 4
    s_mov_b32 s96, 400000
cr_59:
    ds_read_b32 v8, v15 offset:22576
    s_waitcnt lgkmcnt(0)
    v_readfirstlane_b32 s97, v8
    s_cmp_ge_i32 s97, s70
    s_cbranch_scc1 crd_60
    s_sleep 4
    s_sub_u32 s96, s96, 1
    s_cbranch_scc0 cr_59
crd_60:
    s_mov_b32 s96, 400000
cr_61:
    ds_read_b32 v8, v15 offset:22576
    s_waitcnt lgkmcnt(0)
    v_readfirstlane_b32 s97, v8
    s_cmp_ge_i32 s97, s68
    s_cbranch_scc1 crd_62
    s_sleep 1
    s_sub_u32 s96, s96, 1
    s_cbranch_scc0 cr_61
crd_62:
    s_add_i32 s68, s68, 1
    buffer_load_dwordx4 v[128:131], v4, s[4:7], s60 offen offset:0 nt
    buffer_load_dwordx4 v[132:135], v4, s[4:7], s60 offen offset:1024 nt
    buffer_load_dwordx4 v[136:139], v4, s[4:7], s60 offen offset:2048 nt
    buffer_load_dwordx4 v[140:143], v4, s[4:7], s60 offen offset:3072 nt
    buffer_load_dwordx4 v[144:147], v4, s[4:7], s61 offen offset:0 nt
    buffer_load_dwordx4 v[148:151], v4, s[4:7], s61 offen offset:1024 nt
    buffer_load_dwordx4 v[152:155], v4, s[4:7], s61 offen offset:2048 nt
    buffer_load_dwordx4 v[156:159], v4, s[4:7], s61 offen offset:3072 nt
    s_mov_b32 s96, 400000
cr_63:
    ds_read_b32 v8, v15 offset:22576
    s_waitcnt lgkmcnt(0)
    v_readfirstlane_b32 s97, v8
    s_cmp_ge_i32 s97, s68
    s_cbranch_scc1 crd_64
    s_sleep 1
    s_sub_u32 s96, s96, 1
    s_cbranch_scc0 cr_63
crd_64:
    s_add_i32 s68, s68, 1
    buffer_load_dwordx4 v[160:163], v4, s[4:7], s62 offen offset:0 nt
    buffer_load_dwordx4 v[164:167], v4, s[4:7], s62 offen offset:1024 nt
    buffer_load_dwordx4 v[168:171], v4, s[4:7], s62 offen offset:2048 nt
    buffer_load_dwordx4 v[172:175], v4, s[4:7], s62 offen offset:3072 nt
    buffer_load_dwordx4 v[176:179], v4, s[4:7], s63 offen offset:0 nt
    buffer_load_dwordx4 v[180:183], v4, s[4:7], s63 offen offset:1024 nt
    buffer_load_dwordx4 v[184:187], v4, s[4:7], s63 offen offset:2048 nt
    buffer_load_dwordx4 v[188:191], v4, s[4:7], s63 offen offset:3072 nt
    s_mov_b32 s96, 400000
cr_65:
    ds_read_b32 v8, v15 offset:22576
    s_waitcnt lgkmcnt(0)
    v_readfirstlane_b32 s97, v8
    s_cmp_ge_i32 s97, s68
    s_cbranch_scc1 crd_66
    s_sleep 1
    s_sub_u32 s96, s96, 1
    s_cbranch_scc0 cr_65
crd_66:
    s_add_i32 s68, s68, 1
    buffer_load_dwordx4 v[192:195], v4, s[4:7], s64 offen offset:0 nt
    buffer_load_dwordx4 v[196:199], v4, s[4:7], s64 offen offset:1024 nt
    buffer_load_dwordx4 v[200:203], v4, s[4:7], s64 offen offset:2048 nt
    buffer_load_dwordx4 v[204:207], v4, s[4:7], s64 offen offset:3072 nt
    buffer_load_dwordx4 v[208:211], v4, s[4:7], s65 offen offset:0 nt
    buffer_load_dwordx4 v[212:215], v4, s[4:7], s65 offen offset:1024 nt
    buffer_load_dwordx4 v[216:219], v4, s[4:7], s65 offen offset:2048 nt
    buffer_load_dwordx4 v[220:223], v4, s[4:7], s65 offen offset:3072 nt
    s_mov_b32 s96, 400000
cr_67:
    ds_read_b32 v8, v15 offset:22576
    s_waitcnt lgkmcnt(0)
    v_readfirstlane_b32 s97, v8
    s_cmp_ge_i32 s97, s68
    s_cbranch_scc1 crd_68
    s_sleep 1
    s_sub_u32 s96, s96, 1
    s_cbranch_scc0 cr_67
crd_68:
    s_add_i32 s68, s68, 1
    buffer_load_dwordx4 v[224:227], v4, s[4:7], s66 offen offset:0 nt
    buffer_load_dwordx4 v[228:231], v4, s[4:7], s66 offen offset:1024 nt
    buffer_load_dwordx4 v[232:235], v4, s[4:7], s66 offen offset:2048 nt
    buffer_load_dwordx4 v[236:239], v4, s[4:7], s66 offen offset:3072 nt
    buffer_load_dwordx4 v[240:243], v4, s[4:7], s67 offen offset:0 nt
    buffer_load_dwordx4 v[244:247], v4, s[4:7], s67 offen offset:1024 nt
    buffer_load_dwordx4 v[248:251], v4, s[4:7], s67 offen offset:2048 nt
    buffer_load_dwordx4 v[252:255], v4, s[4:7], s67 offen offset:3072 nt
    v_mov_b32 v13, 1
    ds_read_b32 v8, v11 offset:22560
    s_waitcnt lgkmcnt(0)
    v_cmp_ne_u32 vcc, 1, v8
    s_cbranch_vccz L_pok
    s_waitcnt vmcnt(24)
    s_mov_b64 exec, 1
    ds_add_u32 v15, v14 offset:22576
    s_mov_b64 exec, -1
    s_waitcnt vmcnt(16)
    s_mov_b64 exec, 1
    ds_add_u32 v15, v14 offset:22576
    s_mov_b64 exec, -1
    s_waitcnt vmcnt(8)
    s_mov_b64 exec, 1
    ds_add_u32 v15, v14 offset:22576
    s_mov_b64 exec, -1
    v_mov_b32 v13, 0
    s_mov_b32 s96, 400000
spin_69:
    ds_read_b32 v8, v11 offset:22560
    s_waitcnt lgkmcnt(0)
    v_cmp_ne_u32 vcc, 1, v8
    s_cbranch_vccz spind_70
    s_sleep 1
    s_sub_u32 s96, s96, 1
    s_cbranch_scc0 spin_69
spind_70:
L_pok:
    ds_read_b128 v[16:19], v10 offset:5504
    ds_read_b128 v[20:23], v10 offset:5520
    ds_read_b128 v[24:27], v10 offset:5536
    ds_read_b128 v[28:31], v10 offset:5552
    s_waitcnt lgkmcnt(0)
    v_perm_b32 v42, v16, v16, v32
    v_perm_b32 v43, v16, v16, v33
    v_perm_b32 v46, v20, v20, v32
    v_perm_b32 v47, v20, v20, v33
    v_perm_b32 v50, v24, v24, v32
    v_perm_b32 v51, v24, v24, v33
    v_perm_b32 v54, v28, v28, v32
    v_perm_b32 v55, v28, v28, v33
    s_waitcnt vmcnt(31)
    v_mfma_f32_16x16x32_bf16 v[76:79], v[42:45], v[128:131], 0
    v_mfma_f32_16x16x32_bf16 v[80:83], v[40:43], v[128:131], 0
    v_perm_b32 v58, v16, v16, v34
    v_perm_b32 v59, v16, v16, v35
    s_waitcnt vmcnt(30)
    v_mfma_f32_16x16x32_bf16 v[76:79], v[46:49], v[132:135], v[76:79]
    v_mfma_f32_16x16x32_bf16 v[80:83], v[44:47], v[132:135], v[80:83]
    v_perm_b32 v62, v20, v20, v34
    v_perm_b32 v63, v20, v20, v35
    s_waitcnt vmcnt(29)
    v_mfma_f32_16x16x32_bf16 v[76:79], v[50:53], v[136:139], v[76:79]
    v_mfma_f32_16x16x32_bf16 v[80:83], v[48:51], v[136:139], v[80:83]
    v_perm_b32 v66, v24, v24, v34
    v_perm_b32 v67, v24, v24, v35
    s_waitcnt vmcnt(28)
    v_mfma_f32_16x16x32_bf16 v[76:79], v[54:57], v[140:143], v[76:79]
    v_mfma_f32_16x16x32_bf16 v[80:83], v[52:55], v[140:143], v[80:83]
    v_perm_b32 v70, v28, v28, v34
    v_perm_b32 v71, v28, v28, v35
    s_waitcnt vmcnt(27)
    v_mfma_f32_16x16x32_bf16 v[76:79], v[58:61], v[144:147], v[76:79]
    v_mfma_f32_16x16x32_bf16 v[80:83], v[56:59], v[144:147], v[80:83]
    v_perm_b32 v42, v17, v17, v32
    v_perm_b32 v43, v17, v17, v33
    s_waitcnt vmcnt(26)
    v_mfma_f32_16x16x32_bf16 v[76:79], v[62:65], v[148:151], v[76:79]
    v_mfma_f32_16x16x32_bf16 v[80:83], v[60:63], v[148:151], v[80:83]
    v_perm_b32 v46, v21, v21, v32
    v_perm_b32 v47, v21, v21, v33
    s_waitcnt vmcnt(25)
    v_mfma_f32_16x16x32_bf16 v[76:79], v[66:69], v[152:155], v[76:79]
    v_mfma_f32_16x16x32_bf16 v[80:83], v[64:67], v[152:155], v[80:83]
    v_perm_b32 v50, v25, v25, v32
    v_perm_b32 v51, v25, v25, v33
    s_waitcnt vmcnt(24)
    s_mov_b64 exec, 1
    ds_add_u32 v15, v13 offset:22576
    s_mov_b64 exec, -1
    v_mfma_f32_16x16x32_bf16 v[76:79], v[70:73], v[156:159], v[76:79]
    v_mfma_f32_16x16x32_bf16 v[80:83], v[68:71], v[156:159], v[80:83]
    v_perm_b32 v54, v29, v29, v32
    v_perm_b32 v55, v29, v29, v33
    s_waitcnt vmcnt(23)
    v_mfma_f32_16x16x32_bf16 v[76:79], v[42:45], v[160:163], v[76:79]
    v_mfma_f32_16x16x32_bf16 v[80:83], v[40:43], v[160:163], v[80:83]
    v_perm_b32 v58, v17, v17, v34
    v_perm_b32 v59, v17, v17, v35
    s_waitcnt vmcnt(22)
    v_mfma_f32_16x16x32_bf16 v[76:79], v[46:49], v[164:167], v[76:79]
    v_mfma_f32_16x16x32_bf16 v[80:83], v[44:47], v[164:167], v[80:83]
    v_perm_b32 v62, v21, v21, v34
    v_perm_b32 v63, v21, v21, v35
    s_waitcnt vmcnt(21)
    v_mfma_f32_16x16x32_bf16 v[76:79], v[50:53], v[168:171], v[76:79]
    v_mfma_f32_16x16x32_bf16 v[80:83], v[48:51], v[168:171], v[80:83]
    v_perm_b32 v66, v25, v25, v34
    v_perm_b32 v67, v25, v25, v35
    s_waitcnt vmcnt(20)
    v_mfma_f32_16x16x32_bf16 v[76:79], v[54:57], v[172:175], v[76:79]
    v_mfma_f32_16x16x32_bf16 v[80:83], v[52:55], v[172:175], v[80:83]
    v_perm_b32 v70, v29, v29, v34
    v_perm_b32 v71, v29, v29, v35
    s_waitcnt vmcnt(19)
    v_mfma_f32_16x16x32_bf16 v[76:79], v[58:61], v[176:179], v[76:79]
    v_mfma_f32_16x16x32_bf16 v[80:83], v[56:59], v[176:179], v[80:83]
    v_perm_b32 v42, v18, v18, v32
    v_perm_b32 v43, v18, v18, v33
    s_waitcnt vmcnt(18)
    v_mfma_f32_16x16x32_bf16 v[76:79], v[62:65], v[180:183], v[76:79]
    v_mfma_f32_16x16x32_bf16 v[80:83], v[60:63], v[180:183], v[80:83]
    v_perm_b32 v46, v22, v22, v32
    v_perm_b32 v47, v22, v22, v33
    s_waitcnt vmcnt(17)
    v_mfma_f32_16x16x32_bf16 v[76:79], v[66:69], v[184:187], v[76:79]
    v_mfma_f32_16x16x32_bf16 v[80:83], v[64:67], v[184:187], v[80:83]
    v_perm_b32 v50, v26, v26, v32
    v_perm_b32 v51, v26, v26, v33
    s_waitcnt vmcnt(16)
    s_mov_b64 exec, 1
    ds_add_u32 v15, v13 offset:22576
    s_mov_b64 exec, -1
    v_mfma_f32_16x16x32_bf16 v[76:79], v[70:73], v[188:191], v[76:79]
    v_mfma_f32_16x16x32_bf16 v[80:83], v[68:71], v[188:191], v[80:83]
    v_perm_b32 v54, v30, v30, v32
    v_perm_b32 v55, v30, v30, v33
    s_waitcnt vmcnt(15)
    v_mfma_f32_16x16x32_bf16 v[76:79], v[42:45], v[192:195], v[76:79]
    v_mfma_f32_16x16x32_bf16 v[80:83], v[40:43], v[192:195], v[80:83]
    v_perm_b32 v58, v18, v18, v34
    v_perm_b32 v59, v18, v18, v35
    s_waitcnt vmcnt(14)
    v_mfma_f32_16x16x32_bf16 v[76:79], v[46:49], v[196:199], v[76:79]
    v_mfma_f32_16x16x32_bf16 v[80:83], v[44:47], v[196:199], v[80:83]
    v_perm_b32 v62, v22, v22, v34
    v_perm_b32 v63, v22, v22, v35
    s_waitcnt vmcnt(13)
    v_mfma_f32_16x16x32_bf16 v[76:79], v[50:53], v[200:203], v[76:79]
    v_mfma_f32_16x16x32_bf16 v[80:83], v[48:51], v[200:203], v[80:83]
    v_perm_b32 v66, v26, v26, v34
    v_perm_b32 v67, v26, v26, v35
    s_waitcnt vmcnt(12)
    v_mfma_f32_16x16x32_bf16 v[76:79], v[54:57], v[204:207], v[76:79]
    v_mfma_f32_16x16x32_bf16 v[80:83], v[52:55], v[204:207], v[80:83]
    v_perm_b32 v70, v30, v30, v34
    v_perm_b32 v71, v30, v30, v35
    s_waitcnt vmcnt(11)
    v_mfma_f32_16x16x32_bf16 v[76:79], v[58:61], v[208:211], v[76:79]
    v_mfma_f32_16x16x32_bf16 v[80:83], v[56:59], v[208:211], v[80:83]
    v_perm_b32 v42, v19, v19, v32
    v_perm_b32 v43, v19, v19, v33
    s_waitcnt vmcnt(10)
    v_mfma_f32_16x16x32_bf16 v[76:79], v[62:65], v[212:215], v[76:79]
    v_mfma_f32_16x16x32_bf16 v[80:83], v[60:63], v[212:215], v[80:83]
    v_perm_b32 v46, v23, v23, v32
    v_perm_b32 v47, v23, v23, v33
    s_waitcnt vmcnt(9)
    v_mfma_f32_16x16x32_bf16 v[76:79], v[66:69], v[216:219], v[76:79]
    v_mfma_f32_16x16x32_bf16 v[80:83], v[64:67], v[216:219], v[80:83]
    v_perm_b32 v50, v27, v27, v32
    v_perm_b32 v51, v27, v27, v33
    s_waitcnt vmcnt(8)
    s_mov_b64 exec, 1
    ds_add_u32 v15, v13 offset:22576
    s_mov_b64 exec, -1
    v_mfma_f32_16x16x32_bf16 v[76:79], v[70:73], v[220:223], v[76:79]
    v_mfma_f32_16x16x32_bf16 v[80:83], v[68:71], v[220:223], v[80:83]
    v_perm_b32 v54, v31, v31, v32
    v_perm_b32 v55, v31, v31, v33
    s_cmp_lg_u32 s71, 3
    s_cbranch_scc1 L_v3s
    s_mov_b32 s96, 400000
spin_71:
    ds_read_b32 v8, v15 offset:22596
    s_waitcnt lgkmcnt(0)
    v_cmp_ne_u32 vcc, 1, v8
    s_cbranch_vccz spind_72
    s_sleep 1
    s_sub_u32 s96, s96, 1
    s_cbranch_scc0 spin_71
spind_72:
    ds_read_b32 v100, v85 offset:22656
    s_mov_b32 s64, 0x11111111
    s_mov_b32 s65, 0x11111111
    s_mov_b32 s66, 0x00ff00ff
    s_mov_b32 s67, 0x00ff00ff
L_v3s:
    s_waitcnt vmcnt(7)
    v_mfma_f32_16x16x32_bf16 v[76:79], v[42:45], v[224:227], v[76:79]
    v_mfma_f32_16x16x32_bf16 v[80:83], v[40:43], v[224:227], v[80:83]
    v_perm_b32 v58, v19, v19, v34
    v_perm_b32 v59, v19, v19, v35
    s_waitcnt vmcnt(6)
    v_mfma_f32_16x16x32_bf16 v[76:79], v[46:49], v[228:231], v[76:79]
    v_mfma_f32_16x16x32_bf16 v[80:83], v[44:47], v[228:231], v[80:83]
    v_perm_b32 v62, v23, v23, v34
    v_perm_b32 v63, v23, v23, v35
    s_waitcnt vmcnt(5)
    v_mfma_f32_16x16x32_bf16 v[76:79], v[50:53], v[232:235], v[76:79]
    v_mfma_f32_16x16x32_bf16 v[80:83], v[48:51], v[232:235], v[80:83]
    v_perm_b32 v66, v27, v27, v34
    v_perm_b32 v67, v27, v27, v35
    s_waitcnt vmcnt(4)
    v_mfma_f32_16x16x32_bf16 v[76:79], v[54:57], v[236:239], v[76:79]
    v_mfma_f32_16x16x32_bf16 v[80:83], v[52:55], v[236:239], v[80:83]
    v_perm_b32 v70, v31, v31, v34
    v_perm_b32 v71, v31, v31, v35
    s_waitcnt vmcnt(3)
    v_mfma_f32_16x16x32_bf16 v[76:79], v[58:61], v[240:243], v[76:79]
    v_mfma_f32_16x16x32_bf16 v[80:83], v[56:59], v[240:243], v[80:83]
    s_waitcnt vmcnt(2)
    v_mfma_f32_16x16x32_bf16 v[76:79], v[62:65], v[244:247], v[76:79]
    v_mfma_f32_16x16x32_bf16 v[80:83], v[60:63], v[244:247], v[80:83]
    s_waitcnt vmcnt(1)
    v_mfma_f32_16x16x32_bf16 v[76:79], v[66:69], v[248:251], v[76:79]
    v_mfma_f32_16x16x32_bf16 v[80:83], v[64:67], v[248:251], v[80:83]
    s_waitcnt vmcnt(0)
    v_mfma_f32_16x16x32_bf16 v[76:79], v[70:73], v[252:255], v[76:79]
    v_mfma_f32_16x16x32_bf16 v[80:83], v[68:71], v[252:255], v[80:83]
    s_nop 6
    ds_write_b128 v12, v[76:79] offset:10624
    ds_write_b128 v12, v[80:83] offset:11648
    s_mov_b64 exec, 1
    ds_add_u32 v15, v14 offset:22576
    s_mov_b64 exec, -1
    s_cmp_eq_u32 s71, 3
    s_cbranch_scc1 L_wait2
L_wait:
    s_mov_b32 s96, 400000
spin_73:
    ds_read_b32 v8, v15 offset:22596
    s_waitcnt lgkmcnt(0)
    v_cmp_ne_u32 vcc, 1, v8
    s_cbranch_vccz spind_74
    s_sleep 4
    s_sub_u32 s96, s96, 1
    s_cbranch_scc0 spin_73
spind_74:
    ds_read_b32 v100, v85 offset:22656
    s_mov_b32 s64, 0x11111111
    s_mov_b32 s65, 0x11111111
    s_mov_b32 s66, 0x00ff00ff
    s_mov_b32 s67, 0x00ff00ff
    s_mov_b32 s96, 400000
cr_75:
    ds_read_b32 v8, v15 offset:22576
    s_waitcnt lgkmcnt(0)
    v_readfirstlane_b32 s97, v8
    s_cmp_ge_i32 s97, 37
    s_cbranch_scc1 crd_76
    s_sleep 4
    s_sub_u32 s96, s96, 1
    s_cbranch_scc0 cr_75
crd_76:
L_wait2:
    s_mov_b32 s96, 400000
cr_77:
    ds_read_b32 v8, v15 offset:22576
    s_waitcnt lgkmcnt(0)
    v_readfirstlane_b32 s97, v8
    s_cmp_ge_i32 s97, 40
    s_cbranch_scc1 crd_78
    s_sleep 1
    s_sub_u32 s96, s96, 1
    s_cbranch_scc0 cr_77
crd_78:
    s_sleep 2
L_tail:
    s_mov_b32 s96, 40000
L_op:
    buffer_load_dwordx4 v[16:19], v84, s[48:51], s46 offen sc1
    buffer_load_dwordx4 v[20:23], v84, s[48:51], s46 offen offset:1024 sc1
    s_waitcnt vmcnt(1)
    v_msad_u8 v8, v16, s41, 0
    v_msad_u8 v8, v17, s42, v8
    v_msad_u8 v8, v18, s43, v8
    v_msad_u8 v8, v19, s44, v8
    s_waitcnt vmcnt(0)
    v_msad_u8 v8, v20, s41, v8
    v_msad_u8 v8, v21, s42, v8
    v_msad_u8 v8, v22, s43, v8
    v_msad_u8 v8, v23, s44, v8
    v_cmp_ne_u32 vcc, 0, v8
    s_cbranch_vccz L_opd
    s_sub_u32 s96, s96, 1
    s_cbranch_scc0 L_op
L_opd:
    s_waitcnt lgkmcnt(0)
    v_mul_f32 v16, v100, v16
    v_mul_f32 v17, v100, v17
    v_mul_f32 v18, v100, v18
    v_mul_f32 v19, v100, v19
    v_mul_f32 v20, v100, v20
    v_mul_f32 v21, v100, v21
    v_mul_f32 v22, v100, v22
    v_mul_f32 v23, v100, v23
    v_add_f32_dpp v16, v16, v16 quad_perm:[1,0,3,2] row_mask:0xf bank_mask:0xf
    v_add_f32_dpp v17, v17, v17 quad_perm:[1,0,3,2] row_mask:0xf bank_mask:0xf
    v_add_f32_dpp v18, v18, v18 quad_perm:[1,0,3,2] row_mask:0xf bank_mask:0xf
    v_add_f32_dpp v19, v19, v19 quad_perm:[1,0,3,2] row_mask:0xf bank_mask:0xf
    v_add_f32_dpp v20, v20, v20 quad_perm:[1,0,3,2] row_mask:0xf bank_mask:0xf
    v_add_f32_dpp v21, v21, v21 quad_perm:[1,0,3,2] row_mask:0xf bank_mask:0xf
    v_add_f32_dpp v22, v22, v22 quad_perm:[1,0,3,2] row_mask:0xf bank_mask:0xf
    v_add_f32_dpp v23, v23, v23 quad_perm:[1,0,3,2] row_mask:0xf bank_mask:0xf
    v_add_f32_dpp v16, v16, v16 quad_perm:[2,3,0,1] row_mask:0xf bank_mask:0xf
    v_add_f32_dpp v17, v17, v17 quad_perm:[2,3,0,1] row_mask:0xf bank_mask:0xf
    v_add_f32_dpp v18, v18, v18 quad_perm:[2,3,0,1] row_mask:0xf bank_mask:0xf
    v_add_f32_dpp v19, v19, v19 quad_perm:[2,3,0,1] row_mask:0xf bank_mask:0xf
    v_add_f32_dpp v20, v20, v20 quad_perm:[2,3,0,1] row_mask:0xf bank_mask:0xf
    v_add_f32_dpp v21, v21, v21 quad_perm:[2,3,0,1] row_mask:0xf bank_mask:0xf
    v_add_f32_dpp v22, v22, v22 quad_perm:[2,3,0,1] row_mask:0xf bank_mask:0xf
    v_add_f32_dpp v23, v23, v23 quad_perm:[2,3,0,1] row_mask:0xf bank_mask:0xf
    v_cvt_pk_bf16_f32 v24, v16, v17
    v_cvt_pk_bf16_f32 v25, v18, v19
    v_cvt_pk_bf16_f32 v26, v20, v21
    v_cvt_pk_bf16_f32 v27, v22, v23
    s_mov_b64 exec, s[64:65]
    ds_write_b64 v86, v[24:25] offset:18816
    ds_write_b64 v86, v[26:27] offset:18944
    s_mov_b64 exec, 1
    ds_add_u32 v15, v14 offset:22608
    s_mov_b64 exec, -1
    s_lshl_b32 s57, s3, 5
    s_and_b32 s57, s57, 96
    v_xor_b32 v9, s57, v88
    s_mov_b32 s96, 400000
L_tc:
    ds_read_b32 v8, v15 offset:22608
    s_waitcnt lgkmcnt(0)
    v_readfirstlane_b32 s97, v8
    s_and_b32 s57, s97, 15
    s_cmp_ge_u32 s57, 6
    s_cbranch_scc1 L_tcd
    s_sub_u32 s96, s96, 1
    s_cbranch_scc0 L_tc
L_tcd:
    ds_read_b128 v[16:19], v87 offset:18816
    ds_read_b128 v[20:23], v87 offset:18880
    ds_read_b128 v[24:27], v87 offset:18944
    ds_read_b128 v[28:31], v87 offset:19008
    s_cmp_ge_u32 s97, 16
    s_cbranch_scc1 L_twd
L_tw:
    ds_read_b32 v8, v15 offset:22608
    s_waitcnt lgkmcnt(0)
    v_readfirstlane_b32 s97, v8
    s_cmp_ge_u32 s97, 16
    s_cbranch_scc1 L_twd
    s_sub_u32 s96, s96, 1
    s_cbranch_scc0 L_tw
L_twd:
    ds_read_b64_tr_b16 v[36:37], v9 offset:32768
    ds_read_b64_tr_b16 v[38:39], v9 offset:33280
    ds_read_b64_tr_b16 v[40:41], v9 offset:36864
    ds_read_b64_tr_b16 v[42:43], v9 offset:37376
    ds_read_b64_tr_b16 v[44:45], v9 offset:40960
    ds_read_b64_tr_b16 v[46:47], v9 offset:41472
    ds_read_b64_tr_b16 v[48:49], v9 offset:45056
    ds_read_b64_tr_b16 v[50:51], v9 offset:45568
    s_waitcnt lgkmcnt(6)
    v_mfma_f32_16x16x32_bf16 v[32:35], v[36:39], v[16:19], 0
    s_waitcnt lgkmcnt(4)
    v_mfma_f32_16x16x32_bf16 v[32:35], v[40:43], v[20:23], v[32:35]
    s_waitcnt lgkmcnt(2)
    v_mfma_f32_16x16x32_bf16 v[32:35], v[44:47], v[24:27], v[32:35]
    s_waitcnt lgkmcnt(0)
    v_mfma_f32_16x16x32_bf16 v[32:35], v[48:51], v[28:31], v[32:35]
    s_nop 7
    v_bfi_b32 v32, v3, s41, v32
    v_bfi_b32 v33, v3, s42, v33
    v_bfi_b32 v34, v3, s43, v34
    v_bfi_b32 v35, v3, s44, v35
    s_mov_b64 exec, s[66:67]
    buffer_store_dwordx4 v[32:35], v89, s[48:51], s1 offen sc1
    s_mov_b64 exec, -1
L_fin:
L_end:
    s_endpgm

.section .rodata,"a"
.p2align 6
.amdhsa_kernel recurrent_scan__sliding_block_cached__glu_gated_glu__decode_kernel
  .amdhsa_next_free_vgpr 256
  .amdhsa_next_free_sgpr 102
  .amdhsa_accum_offset 256
  .amdhsa_group_segment_fixed_size 0
  .amdhsa_kernarg_size 96
  .amdhsa_user_sgpr_count 2
  .amdhsa_user_sgpr_kernarg_segment_ptr 1
  .amdhsa_system_sgpr_workgroup_id_x 1
.end_amdhsa_kernel
```
